```python
import torch

def _softmax(x, axis=-1):
    return torch.softmax(x, dim=axis)
def _gelu(x):
    return torch.nn.functional.gelu(x, approximate="tanh")
def _silu(x):
    return torch.nn.functional.silu(x)
def _sigmoid(x):
    return torch.sigmoid(x)
def _layernorm(x, axis=-1, eps=1e-5):
    m = x.mean(dim=axis, keepdim=True)
    v = x.var(dim=axis, keepdim=True, unbiased=False)
    return (x - m) / torch.sqrt(v + eps)
def _scatter_add(tgt, idx, src, axis=0):
    return tgt.clone().index_add_(axis, idx, src)
def _segment_sum(src, seg, n):
    out = torch.zeros((n,) + src.shape[1:], dtype=src.dtype)
    return out.index_add_(0, seg, src)
def _pad(x, pw):
    flat = tuple(v for pair in reversed(pw) for v in pair)
    return torch.nn.functional.pad(x, flat)

kernel_name = 'standalone__kv_cache_quant_int4_int2_kv_with_per_channel_or_per_token_scales__decode'

def setup_inputs():

    _w = (lambda a: (lambda t: t.to(torch.bfloat16) if t.is_floating_point() else t)(torch.as_tensor(a)))
    B = 1
    Sq = 1
    Skv = 32768
    Hq = 32
    Hkv = 32
    Dh = 192
    bits = 3
    G = -1
    if G <= 0 or G >= Skv:
        G = max(1, Skv // 2)
    Skv = (Skv // G) * G
    ngk = Skv // G
    qmax = (1 << bits) - 1
    return {
        "q": _w((lambda *s: torch.randn(*s, dtype=torch.bfloat16) * 3.2)(B, Hq, Sq, Dh)),
        "qk": _w(torch.randint(0, qmax + 1, (B, Hkv, Skv, Dh)).to(torch.int32)),
        "qv": _w(torch.randint(0, qmax + 1, (B, Hkv, Skv, Dh)).to(torch.int32)),
        "k_scales": _w(torch.abs((lambda *s: torch.randn(*s, dtype=torch.bfloat16) * 3.2)(B, Hkv, ngk, Dh)) * 0.05 + 0.02),
        "k_zeros": _w((lambda *s: torch.randn(*s, dtype=torch.bfloat16) * 3.2)(B, Hkv, ngk, Dh) + float(qmax) / 2.0),
        "v_scales": _w(torch.abs((lambda *s: torch.randn(*s, dtype=torch.bfloat16) * 0.05)(B, Hkv, Skv, 1)) * 0.05 + 0.02),
        "v_zeros": _w((lambda *s: torch.randn(*s, dtype=torch.bfloat16) * 0.05)(B, Hkv, Skv, 1) + float(qmax) / 2.0),
    }

def reference(q, qk, qv, k_scales, k_zeros, v_scales, v_zeros):
    B, Hq, Sq, Dh = q.shape
    Hkv, Skv = qk.shape[1], qk.shape[2]
    ngk = k_scales.shape[2]
    G = Skv // ngk
    ks = (lambda x, n, axis: torch.repeat_interleave(x, n, dim=axis))(k_scales, G, axis=2)
    kz = (lambda x, n, axis: torch.repeat_interleave(x, n, dim=axis))(k_zeros, G, axis=2)
    k = ((lambda x, dt: x.to(dt))(qk, q.dtype) - kz) * ks
    v = ((lambda x, dt: x.to(dt))(qv, q.dtype) - v_zeros) * v_scales
    rep = Hq // Hkv
    if rep > 1:
        k = (lambda x, n, axis: torch.repeat_interleave(x, n, dim=axis))(k, rep, axis=1)
        v = (lambda x, n, axis: torch.repeat_interleave(x, n, dim=axis))(v, rep, axis=1)
    scale = float(Dh) ** -0.5
    logits = torch.einsum("bhqd,bhkd->bhqk", q, k) * scale
    p = _softmax(logits, axis=-1)
    o = torch.einsum("bhqk,bhkd->bhqd", p, v)
    return o
```

```asm
; @launch grid=(256,1,1) block=(256,1,1) lds=25360
.amdgcn_target "amdgcn-amd-amdhsa--gfx950"
.text
.globl standalone__kv_cache_quant_int4_int2_kv_with_per_channel_or_per_token_scales__decode_kernel
.p2align 8
.type standalone__kv_cache_quant_int4_int2_kv_with_per_channel_or_per_token_scales__decode_kernel,@function
standalone__kv_cache_quant_int4_int2_kv_with_per_channel_or_per_token_scales__decode_kernel:
s_cmp_ge_u32 s2, 256
s_cbranch_scc1 L_exit_standalone__kv_cache_quant_int4_int2_kv_with_per_channel_or_per_token_scales__decode_kernel
s_load_dwordx16 s[32:47], s[0:1], 0
s_load_dwordx4 s[48:51], s[0:1], 64
v_lshrrev_b32 v1, 6, v0
v_and_b32 v3, 15, v0
v_readfirstlane_b32 s3, v1
v_bfe_u32 v5, v0, 4, 2
v_and_b32 v100, 63, v0
v_mul_u32_u24 v1, 0x300, v5
v_lshlrev_b32 v101, 4, v3
v_add_u32 v1, v1, v101
v_and_b32 v6, 15, v3
v_lshrrev_b32 v7, 2, v6
v_and_b32 v6, 3, v6
v_mul_u32_u24 v7, 2048, v7
v_mul_u32_u24 v6, 4, v6
v_add3_u32 v2, v7, v6, v5
v_lshlrev_b32 v2, 1, v2
v_lshlrev_b32 v102, 2, v5
v_add_u32 v103, v101, v102
v_lshlrev_b32 v104, 3, v100
v_lshlrev_b32 v105, 4, v100
s_and_b32 s24, s2, 7
s_lshr_b32 s25, s2, 3
s_mul_i32 s26, s24, 32768
s_mul_i32 s27, s25, 64
s_add_u32 s26, s26, s27
s_mul_i32 s27, s3, 16
s_add_u32 s26, s26, s27
s_lshl_b32 s28, s26, 1
s_mul_i32 s26, s26, 768
s_mul_i32 s30, s3, 2
s_lshr_b32 s5, s30, 1
s_mul_i32 s5, s5, 8
s_add_u32 s5, s5, s24
s_and_b32 s4, s30, 1
s_lshl_b32 s6, s5, 1
s_add_u32 s4, s4, s6
s_mul_i32 s4, s4, 384
s_mul_i32 s5, s5, 384
v_add_u32 v6, s4, v104
v_add_u32 v7, s5, v104
v_mov_b32 v82, 0
v_mov_b32 v83, 0
v_mov_b32 v80, 0
v_mov_b32 v81, 0
v_mov_b32 v41, 0
s_waitcnt lgkmcnt(0)
s_mov_b32 exec_hi, 0xffff
global_load_dwordx2 v[110:111], v7, s[32:33] offset:0
global_load_dwordx2 v[120:121], v6, s[38:39] offset:0
global_load_dwordx2 v[130:131], v6, s[40:41] offset:0
global_load_dwordx2 v[122:123], v6, s[38:39] offset:384
global_load_dwordx2 v[132:133], v6, s[40:41] offset:384
s_mov_b32 exec_hi, -1
s_mov_b32 s8, s34
s_and_b32 s9, s35, 0xffff
s_mov_b32 s10, 805306368
s_mov_b32 s11, 0x20000
s_mov_b32 s12, s36
s_and_b32 s13, s37, 0xffff
s_mov_b32 s14, 805306368
s_mov_b32 s15, 0x20000
s_mov_b32 s16, s42
s_and_b32 s17, s43, 0xffff
s_mov_b32 s18, 2097152
s_mov_b32 s19, 0x20000
s_mov_b32 s20, s44
s_and_b32 s21, s45, 0xffff
s_mov_b32 s22, 2097152
s_mov_b32 s23, 0x20000
buffer_load_dwordx4 v[4:7], v1, s[8:11], s26 offen offset:0 nt
buffer_load_dwordx4 v[8:11], v1, s[8:11], s26 offen offset:256 nt
buffer_load_dwordx4 v[12:15], v1, s[8:11], s26 offen offset:512 nt
s_add_u32 s27, s26, 3072
buffer_load_dwordx4 v[16:19], v1, s[8:11], s27 offen offset:0 nt
buffer_load_dwordx4 v[20:23], v1, s[8:11], s27 offen offset:256 nt
buffer_load_dwordx4 v[24:27], v1, s[8:11], s27 offen offset:512 nt
s_mov_b32 s58, s26
s_mov_b32 s62, 805306368
s_mov_b32 s63, 0x20000
s_mov_b32 s6, 0x3dd53b95
s_mul_i32 s4, s30, 1536
v_add_u32 v106, s4, v105
s_lshl_b32 s5, s24, 2
s_add_u32 s5, s5, s3
s_mul_i32 s7, s5, 32
s_add_u32 s7, s7, s25
s_lshl_b32 s7, s7, 10
s_add_u32 s7, s7, 4194304
v_add_u32 v108, s7, v105
v_mov_b32 v88, 0xffffdead
v_mov_b32 v89, v88
v_mov_b32 v90, v88
v_mov_b32 v91, v88
s_mov_b32 exec_hi, 0x1ffff
global_store_dwordx4 v108, v[88:91], s[50:51] sc1
s_mov_b32 exec_hi, -1
s_waitcnt vmcnt(0)
s_mov_b32 exec_hi, 0xffff
v_lshlrev_b32 v140, 16, v110
v_and_b32 v141, 0xffff0000, v110
v_lshlrev_b32 v142, 16, v111
v_and_b32 v143, 0xffff0000, v111
v_lshlrev_b32 v144, 16, v120
v_and_b32 v145, 0xffff0000, v120
v_lshlrev_b32 v146, 16, v121
v_and_b32 v147, 0xffff0000, v121
v_lshlrev_b32 v148, 16, v130
v_and_b32 v149, 0xffff0000, v130
v_lshlrev_b32 v150, 16, v131
v_and_b32 v151, 0xffff0000, v131
v_mul_f32 v144, v140, v144
v_mul_f32 v145, v141, v145
v_mul_f32 v146, v142, v146
v_mul_f32 v147, v143, v147
v_mul_f32 v152, s6, v144
v_mul_f32 v153, s6, v145
v_mul_f32 v154, s6, v146
v_mul_f32 v155, s6, v147
v_mul_f32_e64 v156, -v152, v148
v_mul_f32_e64 v157, -v153, v149
v_mul_f32_e64 v158, -v154, v150
v_mul_f32_e64 v159, -v155, v151
ds_write_b128 v106, v[152:155] offset:0
ds_write_b128 v106, v[156:159] offset:768
v_lshlrev_b32 v140, 16, v110
v_and_b32 v141, 0xffff0000, v110
v_lshlrev_b32 v142, 16, v111
v_and_b32 v143, 0xffff0000, v111
v_lshlrev_b32 v144, 16, v122
v_and_b32 v145, 0xffff0000, v122
v_lshlrev_b32 v146, 16, v123
v_and_b32 v147, 0xffff0000, v123
v_lshlrev_b32 v148, 16, v132
v_and_b32 v149, 0xffff0000, v132
v_lshlrev_b32 v150, 16, v133
v_and_b32 v151, 0xffff0000, v133
v_mul_f32 v144, v140, v144
v_mul_f32 v145, v141, v145
v_mul_f32 v146, v142, v146
v_mul_f32 v147, v143, v147
v_mul_f32 v160, s6, v144
v_mul_f32 v161, s6, v145
v_mul_f32 v162, s6, v146
v_mul_f32 v163, s6, v147
v_mul_f32_e64 v164, -v160, v148
v_mul_f32_e64 v165, -v161, v149
v_mul_f32_e64 v166, -v162, v150
v_mul_f32_e64 v167, -v163, v151
ds_write_b128 v106, v[160:163] offset:1536
ds_write_b128 v106, v[164:167] offset:2304
s_mov_b32 exec_hi, -1
s_waitcnt lgkmcnt(0)
s_barrier
s_mov_b32 s29, 0
s_mov_b32 s30, 0
s_mul_i32 s56, s3, 800
s_add_u32 s56, s56, 12288
s_mov_b32 s31, s56
L_coef_standalone__kv_cache_quant_int4_int2_kv_with_per_channel_or_per_token_scales__decode_kernel:
v_add_u32 v84, s30, v101
ds_read_b128 v[28:31], v84 offset:0
ds_read_b128 v[32:35], v84 offset:256
ds_read_b128 v[36:39], v84 offset:512
ds_read_b128 v[88:91], v84 offset:768
ds_read_b128 v[92:95], v84 offset:1024
ds_read_b128 v[96:99], v84 offset:1280
s_add_u32 s30, s30, 1536
s_waitcnt lgkmcnt(0)
v_pk_add_f32 v[88:89], v[88:89], v[90:91]
v_pk_add_f32 v[92:93], v[92:93], v[94:95]
v_pk_add_f32 v[96:97], v[96:97], v[98:99]
v_pk_add_f32 v[88:89], v[88:89], v[92:93]
v_pk_add_f32 v[88:89], v[88:89], v[96:97]
v_add_f32 v40, v88, v89
L_kblk_standalone__kv_cache_quant_int4_int2_kv_with_per_channel_or_per_token_scales__decode_kernel:
buffer_load_short_d16_hi v82, v2, s[16:19], s28 offen nt
buffer_load_short_d16_hi v83, v2, s[20:23], s28 offen nt
s_add_u32 s4, s29, 1
s_and_b32 s4, s4, 3
s_cselect_b32 s4, 0, 229376
s_add_u32 s4, s4, 8192
s_mul_i32 s57, s4, 768
s_add_u32 s57, s57, s26
s_lshl_b32 s4, s4, 1
s_add_u32 s28, s28, s4
s_cmp_eq_u32 s29, 15
s_cselect_b32 s57, s58, s57
s_cselect_b32 s60, s12, s8
s_cselect_b32 s61, s13, s9
s_mov_b32 s64, 0x10001
s_mov_b32 s65, 0x10001
s_add_u32 s27, s26, 6144
s_waitcnt vmcnt(7)
v_cvt_f32_i32 v42, v4
v_cvt_f32_i32 v43, v5
v_cvt_f32_i32 v44, v6
v_cvt_f32_i32 v45, v7
buffer_load_dwordx4 v[4:7], v1, s[8:11], s27 offen offset:0 nt
v_pk_fma_f32 v[58:59], v[42:43], v[28:29], v[40:41]
v_pk_fma_f32 v[58:59], v[44:45], v[30:31], v[58:59]
s_waitcnt vmcnt(7)
v_cvt_f32_i32 v46, v8
v_cvt_f32_i32 v47, v9
v_cvt_f32_i32 v48, v10
v_cvt_f32_i32 v49, v11
buffer_load_dwordx4 v[8:11], v1, s[8:11], s27 offen offset:256 nt
v_pk_fma_f32 v[58:59], v[46:47], v[32:33], v[58:59]
v_pk_fma_f32 v[58:59], v[48:49], v[34:35], v[58:59]
s_waitcnt vmcnt(7)
v_cvt_f32_i32 v42, v12
v_cvt_f32_i32 v43, v13
v_cvt_f32_i32 v44, v14
v_cvt_f32_i32 v45, v15
buffer_load_dwordx4 v[12:15], v1, s[8:11], s27 offen offset:512 nt
v_pk_fma_f32 v[58:59], v[42:43], v[36:37], v[58:59]
v_pk_fma_f32 v[58:59], v[44:45], v[38:39], v[58:59]
v_add_f32 v60, v58, v59
s_nop 1
v_add_f32_dpp v60, v60, v60 row_ror:8 row_mask:0xf bank_mask:0xf
s_nop 1
v_add_f32_dpp v60, v60, v60 row_ror:4 row_mask:0xf bank_mask:0xf
s_nop 1
v_add_f32_dpp v60, v60, v60 row_ror:2 row_mask:0xf bank_mask:0xf
s_nop 1
v_add_f32_dpp v60, v60, v60 row_ror:1 row_mask:0xf bank_mask:0xf
v_cndmask_b32 v61, v61, v60, s[64:65]
s_lshl_b64 s[64:65], s[64:65], 1
s_add_u32 s27, s26, 9216
s_waitcnt vmcnt(7)
v_cvt_f32_i32 v42, v16
v_cvt_f32_i32 v43, v17
v_cvt_f32_i32 v44, v18
v_cvt_f32_i32 v45, v19
buffer_load_dwordx4 v[16:19], v1, s[8:11], s27 offen offset:0 nt
v_pk_fma_f32 v[58:59], v[42:43], v[28:29], v[40:41]
v_pk_fma_f32 v[58:59], v[44:45], v[30:31], v[58:59]
s_waitcnt vmcnt(7)
v_cvt_f32_i32 v46, v20
v_cvt_f32_i32 v47, v21
v_cvt_f32_i32 v48, v22
v_cvt_f32_i32 v49, v23
buffer_load_dwordx4 v[20:23], v1, s[8:11], s27 offen offset:256 nt
v_pk_fma_f32 v[58:59], v[46:47], v[32:33], v[58:59]
v_pk_fma_f32 v[58:59], v[48:49], v[34:35], v[58:59]
s_waitcnt vmcnt(7)
v_cvt_f32_i32 v42, v24
v_cvt_f32_i32 v43, v25
v_cvt_f32_i32 v44, v26
v_cvt_f32_i32 v45, v27
buffer_load_dwordx4 v[24:27], v1, s[8:11], s27 offen offset:512 nt
v_pk_fma_f32 v[58:59], v[42:43], v[36:37], v[58:59]
v_pk_fma_f32 v[58:59], v[44:45], v[38:39], v[58:59]
v_add_f32 v60, v58, v59
s_nop 1
v_add_f32_dpp v60, v60, v60 row_ror:8 row_mask:0xf bank_mask:0xf
s_nop 1
v_add_f32_dpp v60, v60, v60 row_ror:4 row_mask:0xf bank_mask:0xf
s_nop 1
v_add_f32_dpp v60, v60, v60 row_ror:2 row_mask:0xf bank_mask:0xf
s_nop 1
v_add_f32_dpp v60, v60, v60 row_ror:1 row_mask:0xf bank_mask:0xf
v_cndmask_b32 v61, v61, v60, s[64:65]
s_lshl_b64 s[64:65], s[64:65], 1
s_add_u32 s27, s26, 1572864
s_waitcnt vmcnt(5)
v_cvt_f32_i32 v42, v4
v_cvt_f32_i32 v43, v5
v_cvt_f32_i32 v44, v6
v_cvt_f32_i32 v45, v7
buffer_load_dwordx4 v[4:7], v1, s[8:11], s27 offen offset:0 nt
v_pk_fma_f32 v[58:59], v[42:43], v[28:29], v[40:41]
v_pk_fma_f32 v[58:59], v[44:45], v[30:31], v[58:59]
s_waitcnt vmcnt(5)
v_cvt_f32_i32 v46, v8
v_cvt_f32_i32 v47, v9
v_cvt_f32_i32 v48, v10
v_cvt_f32_i32 v49, v11
buffer_load_dwordx4 v[8:11], v1, s[8:11], s27 offen offset:256 nt
v_pk_fma_f32 v[58:59], v[46:47], v[32:33], v[58:59]
v_pk_fma_f32 v[58:59], v[48:49], v[34:35], v[58:59]
s_waitcnt vmcnt(5)
v_cvt_f32_i32 v42, v12
v_cvt_f32_i32 v43, v13
v_cvt_f32_i32 v44, v14
v_cvt_f32_i32 v45, v15
buffer_load_dwordx4 v[12:15], v1, s[8:11], s27 offen offset:512 nt
v_pk_fma_f32 v[58:59], v[42:43], v[36:37], v[58:59]
v_pk_fma_f32 v[58:59], v[44:45], v[38:39], v[58:59]
v_add_f32 v60, v58, v59
s_nop 1
v_add_f32_dpp v60, v60, v60 row_ror:8 row_mask:0xf bank_mask:0xf
s_nop 1
v_add_f32_dpp v60, v60, v60 row_ror:4 row_mask:0xf bank_mask:0xf
s_nop 1
v_add_f32_dpp v60, v60, v60 row_ror:2 row_mask:0xf bank_mask:0xf
s_nop 1
v_add_f32_dpp v60, v60, v60 row_ror:1 row_mask:0xf bank_mask:0xf
v_cndmask_b32 v61, v61, v60, s[64:65]
s_lshl_b64 s[64:65], s[64:65], 1
s_add_u32 s27, s26, 1575936
s_waitcnt vmcnt(5)
v_cvt_f32_i32 v42, v16
v_cvt_f32_i32 v43, v17
v_cvt_f32_i32 v44, v18
v_cvt_f32_i32 v45, v19
buffer_load_dwordx4 v[16:19], v1, s[8:11], s27 offen offset:0 nt
v_pk_fma_f32 v[58:59], v[42:43], v[28:29], v[40:41]
v_pk_fma_f32 v[58:59], v[44:45], v[30:31], v[58:59]
s_waitcnt vmcnt(5)
v_cvt_f32_i32 v46, v20
v_cvt_f32_i32 v47, v21
v_cvt_f32_i32 v48, v22
v_cvt_f32_i32 v49, v23
buffer_load_dwordx4 v[20:23], v1, s[8:11], s27 offen offset:256 nt
v_pk_fma_f32 v[58:59], v[46:47], v[32:33], v[58:59]
v_pk_fma_f32 v[58:59], v[48:49], v[34:35], v[58:59]
s_waitcnt vmcnt(5)
v_cvt_f32_i32 v42, v24
v_cvt_f32_i32 v43, v25
v_cvt_f32_i32 v44, v26
v_cvt_f32_i32 v45, v27
buffer_load_dwordx4 v[24:27], v1, s[8:11], s27 offen offset:512 nt
v_pk_fma_f32 v[58:59], v[42:43], v[36:37], v[58:59]
v_pk_fma_f32 v[58:59], v[44:45], v[38:39], v[58:59]
v_add_f32 v60, v58, v59
s_nop 1
v_add_f32_dpp v60, v60, v60 row_ror:8 row_mask:0xf bank_mask:0xf
s_nop 1
v_add_f32_dpp v60, v60, v60 row_ror:4 row_mask:0xf bank_mask:0xf
s_nop 1
v_add_f32_dpp v60, v60, v60 row_ror:2 row_mask:0xf bank_mask:0xf
s_nop 1
v_add_f32_dpp v60, v60, v60 row_ror:1 row_mask:0xf bank_mask:0xf
v_cndmask_b32 v61, v61, v60, s[64:65]
s_lshl_b64 s[64:65], s[64:65], 1
s_add_u32 s27, s26, 1579008
s_waitcnt vmcnt(5)
v_cvt_f32_i32 v42, v4
v_cvt_f32_i32 v43, v5
v_cvt_f32_i32 v44, v6
v_cvt_f32_i32 v45, v7
buffer_load_dwordx4 v[4:7], v1, s[8:11], s27 offen offset:0 nt
v_pk_fma_f32 v[58:59], v[42:43], v[28:29], v[40:41]
v_pk_fma_f32 v[58:59], v[44:45], v[30:31], v[58:59]
s_waitcnt vmcnt(5)
v_cvt_f32_i32 v46, v8
v_cvt_f32_i32 v47, v9
v_cvt_f32_i32 v48, v10
v_cvt_f32_i32 v49, v11
buffer_load_dwordx4 v[8:11], v1, s[8:11], s27 offen offset:256 nt
v_pk_fma_f32 v[58:59], v[46:47], v[32:33], v[58:59]
v_pk_fma_f32 v[58:59], v[48:49], v[34:35], v[58:59]
s_waitcnt vmcnt(5)
v_cvt_f32_i32 v42, v12
v_cvt_f32_i32 v43, v13
v_cvt_f32_i32 v44, v14
v_cvt_f32_i32 v45, v15
buffer_load_dwordx4 v[12:15], v1, s[8:11], s27 offen offset:512 nt
v_pk_fma_f32 v[58:59], v[42:43], v[36:37], v[58:59]
v_pk_fma_f32 v[58:59], v[44:45], v[38:39], v[58:59]
v_add_f32 v60, v58, v59
s_nop 1
v_add_f32_dpp v60, v60, v60 row_ror:8 row_mask:0xf bank_mask:0xf
s_nop 1
v_add_f32_dpp v60, v60, v60 row_ror:4 row_mask:0xf bank_mask:0xf
s_nop 1
v_add_f32_dpp v60, v60, v60 row_ror:2 row_mask:0xf bank_mask:0xf
s_nop 1
v_add_f32_dpp v60, v60, v60 row_ror:1 row_mask:0xf bank_mask:0xf
v_cndmask_b32 v61, v61, v60, s[64:65]
s_lshl_b64 s[64:65], s[64:65], 1
s_add_u32 s27, s26, 1582080
s_waitcnt vmcnt(5)
v_cvt_f32_i32 v42, v16
v_cvt_f32_i32 v43, v17
v_cvt_f32_i32 v44, v18
v_cvt_f32_i32 v45, v19
buffer_load_dwordx4 v[16:19], v1, s[8:11], s27 offen offset:0 nt
v_pk_fma_f32 v[58:59], v[42:43], v[28:29], v[40:41]
v_pk_fma_f32 v[58:59], v[44:45], v[30:31], v[58:59]
s_waitcnt vmcnt(5)
v_cvt_f32_i32 v46, v20
v_cvt_f32_i32 v47, v21
v_cvt_f32_i32 v48, v22
v_cvt_f32_i32 v49, v23
buffer_load_dwordx4 v[20:23], v1, s[8:11], s27 offen offset:256 nt
v_pk_fma_f32 v[58:59], v[46:47], v[32:33], v[58:59]
v_pk_fma_f32 v[58:59], v[48:49], v[34:35], v[58:59]
s_waitcnt vmcnt(5)
v_cvt_f32_i32 v42, v24
v_cvt_f32_i32 v43, v25
v_cvt_f32_i32 v44, v26
v_cvt_f32_i32 v45, v27
buffer_load_dwordx4 v[24:27], v1, s[8:11], s27 offen offset:512 nt
v_pk_fma_f32 v[58:59], v[42:43], v[36:37], v[58:59]
v_pk_fma_f32 v[58:59], v[44:45], v[38:39], v[58:59]
v_add_f32 v60, v58, v59
s_nop 1
v_add_f32_dpp v60, v60, v60 row_ror:8 row_mask:0xf bank_mask:0xf
s_nop 1
v_add_f32_dpp v60, v60, v60 row_ror:4 row_mask:0xf bank_mask:0xf
s_nop 1
v_add_f32_dpp v60, v60, v60 row_ror:2 row_mask:0xf bank_mask:0xf
s_nop 1
v_add_f32_dpp v60, v60, v60 row_ror:1 row_mask:0xf bank_mask:0xf
v_cndmask_b32 v61, v61, v60, s[64:65]
s_lshl_b64 s[64:65], s[64:65], 1
s_add_u32 s27, s26, 3145728
s_waitcnt vmcnt(5)
v_cvt_f32_i32 v42, v4
v_cvt_f32_i32 v43, v5
v_cvt_f32_i32 v44, v6
v_cvt_f32_i32 v45, v7
buffer_load_dwordx4 v[4:7], v1, s[8:11], s27 offen offset:0 nt
v_pk_fma_f32 v[58:59], v[42:43], v[28:29], v[40:41]
v_pk_fma_f32 v[58:59], v[44:45], v[30:31], v[58:59]
s_waitcnt vmcnt(5)
v_cvt_f32_i32 v46, v8
v_cvt_f32_i32 v47, v9
v_cvt_f32_i32 v48, v10
v_cvt_f32_i32 v49, v11
buffer_load_dwordx4 v[8:11], v1, s[8:11], s27 offen offset:256 nt
v_pk_fma_f32 v[58:59], v[46:47], v[32:33], v[58:59]
v_pk_fma_f32 v[58:59], v[48:49], v[34:35], v[58:59]
s_waitcnt vmcnt(5)
v_cvt_f32_i32 v42, v12
v_cvt_f32_i32 v43, v13
v_cvt_f32_i32 v44, v14
v_cvt_f32_i32 v45, v15
buffer_load_dwordx4 v[12:15], v1, s[8:11], s27 offen offset:512 nt
v_pk_fma_f32 v[58:59], v[42:43], v[36:37], v[58:59]
v_pk_fma_f32 v[58:59], v[44:45], v[38:39], v[58:59]
v_add_f32 v60, v58, v59
s_nop 1
v_add_f32_dpp v60, v60, v60 row_ror:8 row_mask:0xf bank_mask:0xf
s_nop 1
v_add_f32_dpp v60, v60, v60 row_ror:4 row_mask:0xf bank_mask:0xf
s_nop 1
v_add_f32_dpp v60, v60, v60 row_ror:2 row_mask:0xf bank_mask:0xf
s_nop 1
v_add_f32_dpp v60, v60, v60 row_ror:1 row_mask:0xf bank_mask:0xf
v_cndmask_b32 v61, v61, v60, s[64:65]
s_lshl_b64 s[64:65], s[64:65], 1
s_add_u32 s27, s26, 3148800
s_waitcnt vmcnt(5)
v_cvt_f32_i32 v42, v16
v_cvt_f32_i32 v43, v17
v_cvt_f32_i32 v44, v18
v_cvt_f32_i32 v45, v19
buffer_load_dwordx4 v[16:19], v1, s[8:11], s27 offen offset:0 nt
v_pk_fma_f32 v[58:59], v[42:43], v[28:29], v[40:41]
v_pk_fma_f32 v[58:59], v[44:45], v[30:31], v[58:59]
s_waitcnt vmcnt(5)
v_cvt_f32_i32 v46, v20
v_cvt_f32_i32 v47, v21
v_cvt_f32_i32 v48, v22
v_cvt_f32_i32 v49, v23
buffer_load_dwordx4 v[20:23], v1, s[8:11], s27 offen offset:256 nt
v_pk_fma_f32 v[58:59], v[46:47], v[32:33], v[58:59]
v_pk_fma_f32 v[58:59], v[48:49], v[34:35], v[58:59]
s_waitcnt vmcnt(5)
v_cvt_f32_i32 v42, v24
v_cvt_f32_i32 v43, v25
v_cvt_f32_i32 v44, v26
v_cvt_f32_i32 v45, v27
buffer_load_dwordx4 v[24:27], v1, s[8:11], s27 offen offset:512 nt
v_pk_fma_f32 v[58:59], v[42:43], v[36:37], v[58:59]
v_pk_fma_f32 v[58:59], v[44:45], v[38:39], v[58:59]
v_add_f32 v60, v58, v59
s_nop 1
v_add_f32_dpp v60, v60, v60 row_ror:8 row_mask:0xf bank_mask:0xf
s_nop 1
v_add_f32_dpp v60, v60, v60 row_ror:4 row_mask:0xf bank_mask:0xf
s_nop 1
v_add_f32_dpp v60, v60, v60 row_ror:2 row_mask:0xf bank_mask:0xf
s_nop 1
v_add_f32_dpp v60, v60, v60 row_ror:1 row_mask:0xf bank_mask:0xf
v_cndmask_b32 v61, v61, v60, s[64:65]
s_lshl_b64 s[64:65], s[64:65], 1
s_add_u32 s27, s26, 3151872
s_waitcnt vmcnt(5)
v_cvt_f32_i32 v42, v4
v_cvt_f32_i32 v43, v5
v_cvt_f32_i32 v44, v6
v_cvt_f32_i32 v45, v7
buffer_load_dwordx4 v[4:7], v1, s[8:11], s27 offen offset:0 nt
v_pk_fma_f32 v[58:59], v[42:43], v[28:29], v[40:41]
v_pk_fma_f32 v[58:59], v[44:45], v[30:31], v[58:59]
s_waitcnt vmcnt(5)
v_cvt_f32_i32 v46, v8
v_cvt_f32_i32 v47, v9
v_cvt_f32_i32 v48, v10
v_cvt_f32_i32 v49, v11
buffer_load_dwordx4 v[8:11], v1, s[8:11], s27 offen offset:256 nt
v_pk_fma_f32 v[58:59], v[46:47], v[32:33], v[58:59]
v_pk_fma_f32 v[58:59], v[48:49], v[34:35], v[58:59]
s_waitcnt vmcnt(5)
v_cvt_f32_i32 v42, v12
v_cvt_f32_i32 v43, v13
v_cvt_f32_i32 v44, v14
v_cvt_f32_i32 v45, v15
buffer_load_dwordx4 v[12:15], v1, s[8:11], s27 offen offset:512 nt
v_pk_fma_f32 v[58:59], v[42:43], v[36:37], v[58:59]
v_pk_fma_f32 v[58:59], v[44:45], v[38:39], v[58:59]
v_add_f32 v60, v58, v59
s_nop 1
v_add_f32_dpp v60, v60, v60 row_ror:8 row_mask:0xf bank_mask:0xf
s_nop 1
v_add_f32_dpp v60, v60, v60 row_ror:4 row_mask:0xf bank_mask:0xf
s_nop 1
v_add_f32_dpp v60, v60, v60 row_ror:2 row_mask:0xf bank_mask:0xf
s_nop 1
v_add_f32_dpp v60, v60, v60 row_ror:1 row_mask:0xf bank_mask:0xf
v_cndmask_b32 v61, v61, v60, s[64:65]
s_lshl_b64 s[64:65], s[64:65], 1
s_add_u32 s27, s26, 3154944
s_waitcnt vmcnt(5)
v_cvt_f32_i32 v42, v16
v_cvt_f32_i32 v43, v17
v_cvt_f32_i32 v44, v18
v_cvt_f32_i32 v45, v19
buffer_load_dwordx4 v[16:19], v1, s[8:11], s27 offen offset:0 nt
v_pk_fma_f32 v[58:59], v[42:43], v[28:29], v[40:41]
v_pk_fma_f32 v[58:59], v[44:45], v[30:31], v[58:59]
s_waitcnt vmcnt(5)
v_cvt_f32_i32 v46, v20
v_cvt_f32_i32 v47, v21
v_cvt_f32_i32 v48, v22
v_cvt_f32_i32 v49, v23
buffer_load_dwordx4 v[20:23], v1, s[8:11], s27 offen offset:256 nt
v_pk_fma_f32 v[58:59], v[46:47], v[32:33], v[58:59]
v_pk_fma_f32 v[58:59], v[48:49], v[34:35], v[58:59]
s_waitcnt vmcnt(5)
v_cvt_f32_i32 v42, v24
v_cvt_f32_i32 v43, v25
v_cvt_f32_i32 v44, v26
v_cvt_f32_i32 v45, v27
buffer_load_dwordx4 v[24:27], v1, s[8:11], s27 offen offset:512 nt
v_pk_fma_f32 v[58:59], v[42:43], v[36:37], v[58:59]
v_pk_fma_f32 v[58:59], v[44:45], v[38:39], v[58:59]
v_add_f32 v60, v58, v59
s_nop 1
v_add_f32_dpp v60, v60, v60 row_ror:8 row_mask:0xf bank_mask:0xf
s_nop 1
v_add_f32_dpp v60, v60, v60 row_ror:4 row_mask:0xf bank_mask:0xf
s_nop 1
v_add_f32_dpp v60, v60, v60 row_ror:2 row_mask:0xf bank_mask:0xf
s_nop 1
v_add_f32_dpp v60, v60, v60 row_ror:1 row_mask:0xf bank_mask:0xf
v_cndmask_b32 v61, v61, v60, s[64:65]
s_lshl_b64 s[64:65], s[64:65], 1
s_add_u32 s27, s26, 4718592
s_waitcnt vmcnt(5)
v_cvt_f32_i32 v42, v4
v_cvt_f32_i32 v43, v5
v_cvt_f32_i32 v44, v6
v_cvt_f32_i32 v45, v7
buffer_load_dwordx4 v[4:7], v1, s[8:11], s27 offen offset:0 nt
v_pk_fma_f32 v[58:59], v[42:43], v[28:29], v[40:41]
v_pk_fma_f32 v[58:59], v[44:45], v[30:31], v[58:59]
s_waitcnt vmcnt(5)
v_cvt_f32_i32 v46, v8
v_cvt_f32_i32 v47, v9
v_cvt_f32_i32 v48, v10
v_cvt_f32_i32 v49, v11
buffer_load_dwordx4 v[8:11], v1, s[8:11], s27 offen offset:256 nt
v_pk_fma_f32 v[58:59], v[46:47], v[32:33], v[58:59]
v_pk_fma_f32 v[58:59], v[48:49], v[34:35], v[58:59]
s_waitcnt vmcnt(5)
v_cvt_f32_i32 v42, v12
v_cvt_f32_i32 v43, v13
v_cvt_f32_i32 v44, v14
v_cvt_f32_i32 v45, v15
buffer_load_dwordx4 v[12:15], v1, s[8:11], s27 offen offset:512 nt
v_pk_fma_f32 v[58:59], v[42:43], v[36:37], v[58:59]
v_pk_fma_f32 v[58:59], v[44:45], v[38:39], v[58:59]
v_add_f32 v60, v58, v59
s_nop 1
v_add_f32_dpp v60, v60, v60 row_ror:8 row_mask:0xf bank_mask:0xf
s_nop 1
v_add_f32_dpp v60, v60, v60 row_ror:4 row_mask:0xf bank_mask:0xf
s_nop 1
v_add_f32_dpp v60, v60, v60 row_ror:2 row_mask:0xf bank_mask:0xf
s_nop 1
v_add_f32_dpp v60, v60, v60 row_ror:1 row_mask:0xf bank_mask:0xf
v_cndmask_b32 v61, v61, v60, s[64:65]
s_lshl_b64 s[64:65], s[64:65], 1
s_add_u32 s27, s26, 4721664
s_waitcnt vmcnt(5)
v_cvt_f32_i32 v42, v16
v_cvt_f32_i32 v43, v17
v_cvt_f32_i32 v44, v18
v_cvt_f32_i32 v45, v19
buffer_load_dwordx4 v[16:19], v1, s[8:11], s27 offen offset:0 nt
v_pk_fma_f32 v[58:59], v[42:43], v[28:29], v[40:41]
v_pk_fma_f32 v[58:59], v[44:45], v[30:31], v[58:59]
s_waitcnt vmcnt(5)
v_cvt_f32_i32 v46, v20
v_cvt_f32_i32 v47, v21
v_cvt_f32_i32 v48, v22
v_cvt_f32_i32 v49, v23
buffer_load_dwordx4 v[20:23], v1, s[8:11], s27 offen offset:256 nt
v_pk_fma_f32 v[58:59], v[46:47], v[32:33], v[58:59]
v_pk_fma_f32 v[58:59], v[48:49], v[34:35], v[58:59]
s_waitcnt vmcnt(5)
v_cvt_f32_i32 v42, v24
v_cvt_f32_i32 v43, v25
v_cvt_f32_i32 v44, v26
v_cvt_f32_i32 v45, v27
buffer_load_dwordx4 v[24:27], v1, s[8:11], s27 offen offset:512 nt
v_pk_fma_f32 v[58:59], v[42:43], v[36:37], v[58:59]
v_pk_fma_f32 v[58:59], v[44:45], v[38:39], v[58:59]
v_add_f32 v60, v58, v59
s_nop 1
v_add_f32_dpp v60, v60, v60 row_ror:8 row_mask:0xf bank_mask:0xf
s_nop 1
v_add_f32_dpp v60, v60, v60 row_ror:4 row_mask:0xf bank_mask:0xf
s_nop 1
v_add_f32_dpp v60, v60, v60 row_ror:2 row_mask:0xf bank_mask:0xf
s_nop 1
v_add_f32_dpp v60, v60, v60 row_ror:1 row_mask:0xf bank_mask:0xf
v_cndmask_b32 v61, v61, v60, s[64:65]
s_lshl_b64 s[64:65], s[64:65], 1
s_add_u32 s27, s26, 4724736
s_waitcnt vmcnt(5)
v_cvt_f32_i32 v42, v4
v_cvt_f32_i32 v43, v5
v_cvt_f32_i32 v44, v6
v_cvt_f32_i32 v45, v7
buffer_load_dwordx4 v[4:7], v1, s[8:11], s27 offen offset:0 nt
v_pk_fma_f32 v[58:59], v[42:43], v[28:29], v[40:41]
v_pk_fma_f32 v[58:59], v[44:45], v[30:31], v[58:59]
s_waitcnt vmcnt(5)
v_cvt_f32_i32 v46, v8
v_cvt_f32_i32 v47, v9
v_cvt_f32_i32 v48, v10
v_cvt_f32_i32 v49, v11
buffer_load_dwordx4 v[8:11], v1, s[8:11], s27 offen offset:256 nt
v_pk_fma_f32 v[58:59], v[46:47], v[32:33], v[58:59]
v_pk_fma_f32 v[58:59], v[48:49], v[34:35], v[58:59]
s_waitcnt vmcnt(5)
v_cvt_f32_i32 v42, v12
v_cvt_f32_i32 v43, v13
v_cvt_f32_i32 v44, v14
v_cvt_f32_i32 v45, v15
buffer_load_dwordx4 v[12:15], v1, s[8:11], s27 offen offset:512 nt
v_pk_fma_f32 v[58:59], v[42:43], v[36:37], v[58:59]
v_pk_fma_f32 v[58:59], v[44:45], v[38:39], v[58:59]
v_add_f32 v60, v58, v59
s_nop 1
v_add_f32_dpp v60, v60, v60 row_ror:8 row_mask:0xf bank_mask:0xf
s_nop 1
v_add_f32_dpp v60, v60, v60 row_ror:4 row_mask:0xf bank_mask:0xf
s_nop 1
v_add_f32_dpp v60, v60, v60 row_ror:2 row_mask:0xf bank_mask:0xf
s_nop 1
v_add_f32_dpp v60, v60, v60 row_ror:1 row_mask:0xf bank_mask:0xf
v_cndmask_b32 v61, v61, v60, s[64:65]
s_lshl_b64 s[64:65], s[64:65], 1
s_add_u32 s27, s26, 4727808
s_waitcnt vmcnt(5)
v_cvt_f32_i32 v42, v16
v_cvt_f32_i32 v43, v17
v_cvt_f32_i32 v44, v18
v_cvt_f32_i32 v45, v19
buffer_load_dwordx4 v[16:19], v1, s[8:11], s27 offen offset:0 nt
v_pk_fma_f32 v[58:59], v[42:43], v[28:29], v[40:41]
v_pk_fma_f32 v[58:59], v[44:45], v[30:31], v[58:59]
s_waitcnt vmcnt(5)
v_cvt_f32_i32 v46, v20
v_cvt_f32_i32 v47, v21
v_cvt_f32_i32 v48, v22
v_cvt_f32_i32 v49, v23
buffer_load_dwordx4 v[20:23], v1, s[8:11], s27 offen offset:256 nt
v_pk_fma_f32 v[58:59], v[46:47], v[32:33], v[58:59]
v_pk_fma_f32 v[58:59], v[48:49], v[34:35], v[58:59]
s_waitcnt vmcnt(5)
v_cvt_f32_i32 v42, v24
v_cvt_f32_i32 v43, v25
v_cvt_f32_i32 v44, v26
v_cvt_f32_i32 v45, v27
buffer_load_dwordx4 v[24:27], v1, s[8:11], s27 offen offset:512 nt
v_pk_fma_f32 v[58:59], v[42:43], v[36:37], v[58:59]
v_pk_fma_f32 v[58:59], v[44:45], v[38:39], v[58:59]
v_add_f32 v60, v58, v59
s_nop 1
v_add_f32_dpp v60, v60, v60 row_ror:8 row_mask:0xf bank_mask:0xf
s_nop 1
v_add_f32_dpp v60, v60, v60 row_ror:4 row_mask:0xf bank_mask:0xf
s_nop 1
v_add_f32_dpp v60, v60, v60 row_ror:2 row_mask:0xf bank_mask:0xf
s_nop 1
v_add_f32_dpp v60, v60, v60 row_ror:1 row_mask:0xf bank_mask:0xf
v_cndmask_b32 v61, v61, v60, s[64:65]
s_lshl_b64 s[64:65], s[64:65], 1
s_mov_b32 s27, s57
s_waitcnt vmcnt(5)
v_cvt_f32_i32 v42, v4
v_cvt_f32_i32 v43, v5
v_cvt_f32_i32 v44, v6
v_cvt_f32_i32 v45, v7
buffer_load_dwordx4 v[4:7], v1, s[60:63], s27 offen offset:0 nt
v_pk_fma_f32 v[58:59], v[42:43], v[28:29], v[40:41]
v_pk_fma_f32 v[58:59], v[44:45], v[30:31], v[58:59]
s_waitcnt vmcnt(5)
v_cvt_f32_i32 v46, v8
v_cvt_f32_i32 v47, v9
v_cvt_f32_i32 v48, v10
v_cvt_f32_i32 v49, v11
buffer_load_dwordx4 v[8:11], v1, s[60:63], s27 offen offset:256 nt
v_pk_fma_f32 v[58:59], v[46:47], v[32:33], v[58:59]
v_pk_fma_f32 v[58:59], v[48:49], v[34:35], v[58:59]
s_waitcnt vmcnt(5)
v_cvt_f32_i32 v42, v12
v_cvt_f32_i32 v43, v13
v_cvt_f32_i32 v44, v14
v_cvt_f32_i32 v45, v15
buffer_load_dwordx4 v[12:15], v1, s[60:63], s27 offen offset:512 nt
v_pk_fma_f32 v[58:59], v[42:43], v[36:37], v[58:59]
v_pk_fma_f32 v[58:59], v[44:45], v[38:39], v[58:59]
v_add_f32 v60, v58, v59
s_nop 1
v_add_f32_dpp v60, v60, v60 row_ror:8 row_mask:0xf bank_mask:0xf
s_nop 1
v_add_f32_dpp v60, v60, v60 row_ror:4 row_mask:0xf bank_mask:0xf
s_nop 1
v_add_f32_dpp v60, v60, v60 row_ror:2 row_mask:0xf bank_mask:0xf
s_nop 1
v_add_f32_dpp v60, v60, v60 row_ror:1 row_mask:0xf bank_mask:0xf
v_cndmask_b32 v61, v61, v60, s[64:65]
s_lshl_b64 s[64:65], s[64:65], 1
s_add_u32 s27, s57, 3072
s_waitcnt vmcnt(5)
v_cvt_f32_i32 v42, v16
v_cvt_f32_i32 v43, v17
v_cvt_f32_i32 v44, v18
v_cvt_f32_i32 v45, v19
buffer_load_dwordx4 v[16:19], v1, s[60:63], s27 offen offset:0 nt
v_pk_fma_f32 v[58:59], v[42:43], v[28:29], v[40:41]
v_pk_fma_f32 v[58:59], v[44:45], v[30:31], v[58:59]
s_waitcnt vmcnt(5)
v_cvt_f32_i32 v46, v20
v_cvt_f32_i32 v47, v21
v_cvt_f32_i32 v48, v22
v_cvt_f32_i32 v49, v23
buffer_load_dwordx4 v[20:23], v1, s[60:63], s27 offen offset:256 nt
v_pk_fma_f32 v[58:59], v[46:47], v[32:33], v[58:59]
v_pk_fma_f32 v[58:59], v[48:49], v[34:35], v[58:59]
s_waitcnt vmcnt(5)
v_cvt_f32_i32 v42, v24
v_cvt_f32_i32 v43, v25
v_cvt_f32_i32 v44, v26
v_cvt_f32_i32 v45, v27
buffer_load_dwordx4 v[24:27], v1, s[60:63], s27 offen offset:512 nt
v_pk_fma_f32 v[58:59], v[42:43], v[36:37], v[58:59]
v_pk_fma_f32 v[58:59], v[44:45], v[38:39], v[58:59]
v_add_f32 v60, v58, v59
s_nop 1
v_add_f32_dpp v60, v60, v60 row_ror:8 row_mask:0xf bank_mask:0xf
s_nop 1
v_add_f32_dpp v60, v60, v60 row_ror:4 row_mask:0xf bank_mask:0xf
s_nop 1
v_add_f32_dpp v60, v60, v60 row_ror:2 row_mask:0xf bank_mask:0xf
s_nop 1
v_add_f32_dpp v60, v60, v60 row_ror:1 row_mask:0xf bank_mask:0xf
v_cndmask_b32 v61, v61, v60, s[64:65]
v_mov_b32 v128, v129
v_mov_b32 v129, v130
v_mov_b32 v130, v131
v_mov_b32 v131, v61
v_mov_b32 v136, v137
v_mov_b32 v137, v138
v_mov_b32 v138, v139
v_mov_b32 v139, v82
v_mov_b32 v144, v145
v_mov_b32 v145, v146
v_mov_b32 v146, v147
v_mov_b32 v147, v83
s_mov_b32 s26, s57
s_add_u32 s29, s29, 1
s_and_b32 s4, s29, 1
s_cbranch_scc1 L_kblk_standalone__kv_cache_quant_int4_int2_kv_with_per_channel_or_per_token_scales__decode_kernel
s_and_b32 s4, s29, 3
s_cbranch_scc1 L_coef_standalone__kv_cache_quant_int4_int2_kv_with_per_channel_or_per_token_scales__decode_kernel
v_max_f32 v84, v128, v129
v_max3_f32 v84, v84, v130, v131
s_nop 1
v_max_f32_dpp v84, v84, v84 row_ror:8 row_mask:0xf bank_mask:0xf
s_nop 1
v_max_f32_dpp v84, v84, v84 row_ror:4 row_mask:0xf bank_mask:0xf
s_nop 1
v_max_f32_dpp v84, v84, v84 row_ror:2 row_mask:0xf bank_mask:0xf
s_nop 1
v_max_f32_dpp v84, v84, v84 row_ror:1 row_mask:0xf bank_mask:0xf
v_mov_b32 v85, v84
s_nop 1
v_permlane32_swap_b32 v84, v85
s_nop 1
v_max_f32 v84, v84, v85
v_mov_b32 v85, v84
s_nop 1
v_permlane16_swap_b32 v84, v85
s_nop 1
v_max_f32 v84, v84, v85
v_mov_b32 v112, v116
v_mov_b32 v113, v117
v_mov_b32 v114, v118
v_mov_b32 v115, v119
v_mov_b32 v116, v120
v_mov_b32 v117, v121
v_mov_b32 v118, v122
v_mov_b32 v119, v123
v_mov_b32 v120, v124
v_mov_b32 v121, v125
v_mov_b32 v122, v126
v_mov_b32 v123, v127
v_sub_f32 v128, v128, v84
v_sub_f32 v129, v129, v84
v_sub_f32 v130, v130, v84
v_sub_f32 v131, v131, v84
v_exp_f32 v128, v128
v_exp_f32 v129, v129
v_exp_f32 v130, v130
v_exp_f32 v131, v131
s_nop 0
v_mul_f32 v124, v128, v136
v_mul_f32 v125, v129, v137
v_mul_f32 v126, v130, v138
v_mul_f32 v127, v131, v139
v_add_f32 v62, v128, v129
v_mul_f32 v63, v124, v144
v_add_f32 v62, v62, v130
v_add_f32 v62, v62, v131
v_fmac_f32 v63, v125, v145
v_fmac_f32 v63, v126, v146
v_fmac_f32 v63, v127, v147
s_nop 1
v_add_f32_dpp v62, v62, v62 row_ror:8 row_mask:0xf bank_mask:0xf
v_add_f32_dpp v63, v63, v63 row_ror:8 row_mask:0xf bank_mask:0xf
s_nop 1
v_add_f32_dpp v62, v62, v62 row_ror:4 row_mask:0xf bank_mask:0xf
v_add_f32_dpp v63, v63, v63 row_ror:4 row_mask:0xf bank_mask:0xf
s_nop 1
v_add_f32_dpp v62, v62, v62 row_ror:2 row_mask:0xf bank_mask:0xf
v_add_f32_dpp v63, v63, v63 row_ror:2 row_mask:0xf bank_mask:0xf
s_nop 1
v_add_f32_dpp v62, v62, v62 row_ror:1 row_mask:0xf bank_mask:0xf
v_add_f32_dpp v63, v63, v63 row_ror:1 row_mask:0xf bank_mask:0xf
v_mov_b32 v152, v153
v_mov_b32 v153, v154
v_mov_b32 v154, v155
v_sub_f32 v155, 0, v63
v_add_u32 v85, s31, v102
v_mov_b32 v86, s31
ds_write_b32 v85, v62 offset:768
ds_write_b32 v86, v84 offset:784
s_add_u32 s31, s31, 3200
s_cmp_lt_u32 s29, 16
s_cbranch_scc1 L_coef_standalone__kv_cache_quant_int4_int2_kv_with_per_channel_or_per_token_scales__decode_kernel
s_mov_b32 s29, 0
s_mov_b32 s31, s56
s_mov_b32 s66, 15
L_vhead_standalone__kv_cache_quant_int4_int2_kv_with_per_channel_or_per_token_scales__decode_kernel:
v_mov_b32 v68, v152
v_mov_b32 v69, v152
v_mov_b32 v70, v152
v_mov_b32 v71, v152
v_mov_b32 v72, v152
v_mov_b32 v73, v152
v_mov_b32 v74, v152
v_mov_b32 v75, v152
v_mov_b32 v76, v152
v_mov_b32 v77, v152
v_mov_b32 v78, v152
v_mov_b32 v79, v152
v_mov_b32 v152, v153
v_mov_b32 v153, v154
v_mov_b32 v154, v155
L_vblk_standalone__kv_cache_quant_int4_int2_kv_with_per_channel_or_per_token_scales__decode_kernel:
s_cmp_ge_u32 s29, 15
s_cbranch_scc1 L_deep_standalone__kv_cache_quant_int4_int2_kv_with_per_channel_or_per_token_scales__decode_kernel
s_add_u32 s4, s29, 1
s_and_b32 s4, s4, 3
s_cselect_b32 s4, 0, 229376
s_add_u32 s4, s4, 8192
s_mul_i32 s57, s4, 768
s_add_u32 s57, s57, s26
s_nop 1
s_add_u32 s27, s26, 6144
v_mov_b32_dpp v64, v112 row_newbcast:0 row_mask:0xf bank_mask:0xf
s_waitcnt vmcnt(5)
v_cvt_f32_i32 v42, v4
v_cvt_f32_i32 v43, v5
v_cvt_f32_i32 v44, v6
v_cvt_f32_i32 v45, v7
buffer_load_dwordx4 v[4:7], v1, s[12:15], s27 offen offset:0 nt
v_pk_fma_f32 v[68:69], v[42:43], v[64:65], v[68:69] op_sel_hi:[1,0,1]
v_pk_fma_f32 v[70:71], v[44:45], v[64:65], v[70:71] op_sel_hi:[1,0,1]
s_waitcnt vmcnt(5)
v_cvt_f32_i32 v46, v8
v_cvt_f32_i32 v47, v9
v_cvt_f32_i32 v48, v10
v_cvt_f32_i32 v49, v11
buffer_load_dwordx4 v[8:11], v1, s[12:15], s27 offen offset:256 nt
v_pk_fma_f32 v[72:73], v[46:47], v[64:65], v[72:73] op_sel_hi:[1,0,1]
v_pk_fma_f32 v[74:75], v[48:49], v[64:65], v[74:75] op_sel_hi:[1,0,1]
s_waitcnt vmcnt(5)
v_cvt_f32_i32 v42, v12
v_cvt_f32_i32 v43, v13
v_cvt_f32_i32 v44, v14
v_cvt_f32_i32 v45, v15
buffer_load_dwordx4 v[12:15], v1, s[12:15], s27 offen offset:512 nt
v_pk_fma_f32 v[76:77], v[42:43], v[64:65], v[76:77] op_sel_hi:[1,0,1]
v_pk_fma_f32 v[78:79], v[44:45], v[64:65], v[78:79] op_sel_hi:[1,0,1]
s_add_u32 s27, s26, 9216
v_mov_b32_dpp v64, v112 row_newbcast:1 row_mask:0xf bank_mask:0xf
s_waitcnt vmcnt(5)
v_cvt_f32_i32 v42, v16
v_cvt_f32_i32 v43, v17
v_cvt_f32_i32 v44, v18
v_cvt_f32_i32 v45, v19
buffer_load_dwordx4 v[16:19], v1, s[12:15], s27 offen offset:0 nt
v_pk_fma_f32 v[68:69], v[42:43], v[64:65], v[68:69] op_sel_hi:[1,0,1]
v_pk_fma_f32 v[70:71], v[44:45], v[64:65], v[70:71] op_sel_hi:[1,0,1]
s_waitcnt vmcnt(5)
v_cvt_f32_i32 v46, v20
v_cvt_f32_i32 v47, v21
v_cvt_f32_i32 v48, v22
v_cvt_f32_i32 v49, v23
buffer_load_dwordx4 v[20:23], v1, s[12:15], s27 offen offset:256 nt
v_pk_fma_f32 v[72:73], v[46:47], v[64:65], v[72:73] op_sel_hi:[1,0,1]
v_pk_fma_f32 v[74:75], v[48:49], v[64:65], v[74:75] op_sel_hi:[1,0,1]
s_waitcnt vmcnt(5)
v_cvt_f32_i32 v42, v24
v_cvt_f32_i32 v43, v25
v_cvt_f32_i32 v44, v26
v_cvt_f32_i32 v45, v27
buffer_load_dwordx4 v[24:27], v1, s[12:15], s27 offen offset:512 nt
v_pk_fma_f32 v[76:77], v[42:43], v[64:65], v[76:77] op_sel_hi:[1,0,1]
v_pk_fma_f32 v[78:79], v[44:45], v[64:65], v[78:79] op_sel_hi:[1,0,1]
s_add_u32 s27, s26, 1572864
v_mov_b32_dpp v64, v112 row_newbcast:2 row_mask:0xf bank_mask:0xf
s_waitcnt vmcnt(5)
v_cvt_f32_i32 v42, v4
v_cvt_f32_i32 v43, v5
v_cvt_f32_i32 v44, v6
v_cvt_f32_i32 v45, v7
buffer_load_dwordx4 v[4:7], v1, s[12:15], s27 offen offset:0 nt
v_pk_fma_f32 v[68:69], v[42:43], v[64:65], v[68:69] op_sel_hi:[1,0,1]
v_pk_fma_f32 v[70:71], v[44:45], v[64:65], v[70:71] op_sel_hi:[1,0,1]
s_waitcnt vmcnt(5)
v_cvt_f32_i32 v46, v8
v_cvt_f32_i32 v47, v9
v_cvt_f32_i32 v48, v10
v_cvt_f32_i32 v49, v11
buffer_load_dwordx4 v[8:11], v1, s[12:15], s27 offen offset:256 nt
v_pk_fma_f32 v[72:73], v[46:47], v[64:65], v[72:73] op_sel_hi:[1,0,1]
v_pk_fma_f32 v[74:75], v[48:49], v[64:65], v[74:75] op_sel_hi:[1,0,1]
s_waitcnt vmcnt(5)
v_cvt_f32_i32 v42, v12
v_cvt_f32_i32 v43, v13
v_cvt_f32_i32 v44, v14
v_cvt_f32_i32 v45, v15
buffer_load_dwordx4 v[12:15], v1, s[12:15], s27 offen offset:512 nt
v_pk_fma_f32 v[76:77], v[42:43], v[64:65], v[76:77] op_sel_hi:[1,0,1]
v_pk_fma_f32 v[78:79], v[44:45], v[64:65], v[78:79] op_sel_hi:[1,0,1]
s_add_u32 s27, s26, 1575936
v_mov_b32_dpp v64, v112 row_newbcast:3 row_mask:0xf bank_mask:0xf
s_waitcnt vmcnt(5)
v_cvt_f32_i32 v42, v16
v_cvt_f32_i32 v43, v17
v_cvt_f32_i32 v44, v18
v_cvt_f32_i32 v45, v19
buffer_load_dwordx4 v[16:19], v1, s[12:15], s27 offen offset:0 nt
v_pk_fma_f32 v[68:69], v[42:43], v[64:65], v[68:69] op_sel_hi:[1,0,1]
v_pk_fma_f32 v[70:71], v[44:45], v[64:65], v[70:71] op_sel_hi:[1,0,1]
s_waitcnt vmcnt(5)
v_cvt_f32_i32 v46, v20
v_cvt_f32_i32 v47, v21
v_cvt_f32_i32 v48, v22
v_cvt_f32_i32 v49, v23
buffer_load_dwordx4 v[20:23], v1, s[12:15], s27 offen offset:256 nt
v_pk_fma_f32 v[72:73], v[46:47], v[64:65], v[72:73] op_sel_hi:[1,0,1]
v_pk_fma_f32 v[74:75], v[48:49], v[64:65], v[74:75] op_sel_hi:[1,0,1]
s_waitcnt vmcnt(5)
v_cvt_f32_i32 v42, v24
v_cvt_f32_i32 v43, v25
v_cvt_f32_i32 v44, v26
v_cvt_f32_i32 v45, v27
buffer_load_dwordx4 v[24:27], v1, s[12:15], s27 offen offset:512 nt
v_pk_fma_f32 v[76:77], v[42:43], v[64:65], v[76:77] op_sel_hi:[1,0,1]
v_pk_fma_f32 v[78:79], v[44:45], v[64:65], v[78:79] op_sel_hi:[1,0,1]
s_add_u32 s27, s26, 1579008
v_mov_b32_dpp v64, v112 row_newbcast:4 row_mask:0xf bank_mask:0xf
s_waitcnt vmcnt(5)
v_cvt_f32_i32 v42, v4
v_cvt_f32_i32 v43, v5
v_cvt_f32_i32 v44, v6
v_cvt_f32_i32 v45, v7
buffer_load_dwordx4 v[4:7], v1, s[12:15], s27 offen offset:0 nt
v_pk_fma_f32 v[68:69], v[42:43], v[64:65], v[68:69] op_sel_hi:[1,0,1]
v_pk_fma_f32 v[70:71], v[44:45], v[64:65], v[70:71] op_sel_hi:[1,0,1]
s_waitcnt vmcnt(5)
v_cvt_f32_i32 v46, v8
v_cvt_f32_i32 v47, v9
v_cvt_f32_i32 v48, v10
v_cvt_f32_i32 v49, v11
buffer_load_dwordx4 v[8:11], v1, s[12:15], s27 offen offset:256 nt
v_pk_fma_f32 v[72:73], v[46:47], v[64:65], v[72:73] op_sel_hi:[1,0,1]
v_pk_fma_f32 v[74:75], v[48:49], v[64:65], v[74:75] op_sel_hi:[1,0,1]
s_waitcnt vmcnt(5)
v_cvt_f32_i32 v42, v12
v_cvt_f32_i32 v43, v13
v_cvt_f32_i32 v44, v14
v_cvt_f32_i32 v45, v15
buffer_load_dwordx4 v[12:15], v1, s[12:15], s27 offen offset:512 nt
v_pk_fma_f32 v[76:77], v[42:43], v[64:65], v[76:77] op_sel_hi:[1,0,1]
v_pk_fma_f32 v[78:79], v[44:45], v[64:65], v[78:79] op_sel_hi:[1,0,1]
s_add_u32 s27, s26, 1582080
v_mov_b32_dpp v64, v112 row_newbcast:5 row_mask:0xf bank_mask:0xf
s_waitcnt vmcnt(5)
v_cvt_f32_i32 v42, v16
v_cvt_f32_i32 v43, v17
v_cvt_f32_i32 v44, v18
v_cvt_f32_i32 v45, v19
buffer_load_dwordx4 v[16:19], v1, s[12:15], s27 offen offset:0 nt
v_pk_fma_f32 v[68:69], v[42:43], v[64:65], v[68:69] op_sel_hi:[1,0,1]
v_pk_fma_f32 v[70:71], v[44:45], v[64:65], v[70:71] op_sel_hi:[1,0,1]
s_waitcnt vmcnt(5)
v_cvt_f32_i32 v46, v20
v_cvt_f32_i32 v47, v21
v_cvt_f32_i32 v48, v22
v_cvt_f32_i32 v49, v23
buffer_load_dwordx4 v[20:23], v1, s[12:15], s27 offen offset:256 nt
v_pk_fma_f32 v[72:73], v[46:47], v[64:65], v[72:73] op_sel_hi:[1,0,1]
v_pk_fma_f32 v[74:75], v[48:49], v[64:65], v[74:75] op_sel_hi:[1,0,1]
s_waitcnt vmcnt(5)
v_cvt_f32_i32 v42, v24
v_cvt_f32_i32 v43, v25
v_cvt_f32_i32 v44, v26
v_cvt_f32_i32 v45, v27
buffer_load_dwordx4 v[24:27], v1, s[12:15], s27 offen offset:512 nt
v_pk_fma_f32 v[76:77], v[42:43], v[64:65], v[76:77] op_sel_hi:[1,0,1]
v_pk_fma_f32 v[78:79], v[44:45], v[64:65], v[78:79] op_sel_hi:[1,0,1]
s_add_u32 s27, s26, 3145728
v_mov_b32_dpp v64, v112 row_newbcast:6 row_mask:0xf bank_mask:0xf
s_waitcnt vmcnt(5)
v_cvt_f32_i32 v42, v4
v_cvt_f32_i32 v43, v5
v_cvt_f32_i32 v44, v6
v_cvt_f32_i32 v45, v7
buffer_load_dwordx4 v[4:7], v1, s[12:15], s27 offen offset:0 nt
v_pk_fma_f32 v[68:69], v[42:43], v[64:65], v[68:69] op_sel_hi:[1,0,1]
v_pk_fma_f32 v[70:71], v[44:45], v[64:65], v[70:71] op_sel_hi:[1,0,1]
s_waitcnt vmcnt(5)
v_cvt_f32_i32 v46, v8
v_cvt_f32_i32 v47, v9
v_cvt_f32_i32 v48, v10
v_cvt_f32_i32 v49, v11
buffer_load_dwordx4 v[8:11], v1, s[12:15], s27 offen offset:256 nt
v_pk_fma_f32 v[72:73], v[46:47], v[64:65], v[72:73] op_sel_hi:[1,0,1]
v_pk_fma_f32 v[74:75], v[48:49], v[64:65], v[74:75] op_sel_hi:[1,0,1]
s_waitcnt vmcnt(5)
v_cvt_f32_i32 v42, v12
v_cvt_f32_i32 v43, v13
v_cvt_f32_i32 v44, v14
v_cvt_f32_i32 v45, v15
buffer_load_dwordx4 v[12:15], v1, s[12:15], s27 offen offset:512 nt
v_pk_fma_f32 v[76:77], v[42:43], v[64:65], v[76:77] op_sel_hi:[1,0,1]
v_pk_fma_f32 v[78:79], v[44:45], v[64:65], v[78:79] op_sel_hi:[1,0,1]
s_add_u32 s27, s26, 3148800
v_mov_b32_dpp v64, v112 row_newbcast:7 row_mask:0xf bank_mask:0xf
s_waitcnt vmcnt(5)
v_cvt_f32_i32 v42, v16
v_cvt_f32_i32 v43, v17
v_cvt_f32_i32 v44, v18
v_cvt_f32_i32 v45, v19
buffer_load_dwordx4 v[16:19], v1, s[12:15], s27 offen offset:0 nt
v_pk_fma_f32 v[68:69], v[42:43], v[64:65], v[68:69] op_sel_hi:[1,0,1]
v_pk_fma_f32 v[70:71], v[44:45], v[64:65], v[70:71] op_sel_hi:[1,0,1]
s_waitcnt vmcnt(5)
v_cvt_f32_i32 v46, v20
v_cvt_f32_i32 v47, v21
v_cvt_f32_i32 v48, v22
v_cvt_f32_i32 v49, v23
buffer_load_dwordx4 v[20:23], v1, s[12:15], s27 offen offset:256 nt
v_pk_fma_f32 v[72:73], v[46:47], v[64:65], v[72:73] op_sel_hi:[1,0,1]
v_pk_fma_f32 v[74:75], v[48:49], v[64:65], v[74:75] op_sel_hi:[1,0,1]
s_waitcnt vmcnt(5)
v_cvt_f32_i32 v42, v24
v_cvt_f32_i32 v43, v25
v_cvt_f32_i32 v44, v26
v_cvt_f32_i32 v45, v27
buffer_load_dwordx4 v[24:27], v1, s[12:15], s27 offen offset:512 nt
v_pk_fma_f32 v[76:77], v[42:43], v[64:65], v[76:77] op_sel_hi:[1,0,1]
v_pk_fma_f32 v[78:79], v[44:45], v[64:65], v[78:79] op_sel_hi:[1,0,1]
s_add_u32 s27, s26, 3151872
v_mov_b32_dpp v64, v112 row_newbcast:8 row_mask:0xf bank_mask:0xf
s_waitcnt vmcnt(5)
v_cvt_f32_i32 v42, v4
v_cvt_f32_i32 v43, v5
v_cvt_f32_i32 v44, v6
v_cvt_f32_i32 v45, v7
buffer_load_dwordx4 v[4:7], v1, s[12:15], s27 offen offset:0 nt
v_pk_fma_f32 v[68:69], v[42:43], v[64:65], v[68:69] op_sel_hi:[1,0,1]
v_pk_fma_f32 v[70:71], v[44:45], v[64:65], v[70:71] op_sel_hi:[1,0,1]
s_waitcnt vmcnt(5)
v_cvt_f32_i32 v46, v8
v_cvt_f32_i32 v47, v9
v_cvt_f32_i32 v48, v10
v_cvt_f32_i32 v49, v11
buffer_load_dwordx4 v[8:11], v1, s[12:15], s27 offen offset:256 nt
v_pk_fma_f32 v[72:73], v[46:47], v[64:65], v[72:73] op_sel_hi:[1,0,1]
v_pk_fma_f32 v[74:75], v[48:49], v[64:65], v[74:75] op_sel_hi:[1,0,1]
s_waitcnt vmcnt(5)
v_cvt_f32_i32 v42, v12
v_cvt_f32_i32 v43, v13
v_cvt_f32_i32 v44, v14
v_cvt_f32_i32 v45, v15
buffer_load_dwordx4 v[12:15], v1, s[12:15], s27 offen offset:512 nt
v_pk_fma_f32 v[76:77], v[42:43], v[64:65], v[76:77] op_sel_hi:[1,0,1]
v_pk_fma_f32 v[78:79], v[44:45], v[64:65], v[78:79] op_sel_hi:[1,0,1]
s_add_u32 s27, s26, 3154944
v_mov_b32_dpp v64, v112 row_newbcast:9 row_mask:0xf bank_mask:0xf
s_waitcnt vmcnt(5)
v_cvt_f32_i32 v42, v16
v_cvt_f32_i32 v43, v17
v_cvt_f32_i32 v44, v18
v_cvt_f32_i32 v45, v19
buffer_load_dwordx4 v[16:19], v1, s[12:15], s27 offen offset:0 nt
v_pk_fma_f32 v[68:69], v[42:43], v[64:65], v[68:69] op_sel_hi:[1,0,1]
v_pk_fma_f32 v[70:71], v[44:45], v[64:65], v[70:71] op_sel_hi:[1,0,1]
s_waitcnt vmcnt(5)
v_cvt_f32_i32 v46, v20
v_cvt_f32_i32 v47, v21
v_cvt_f32_i32 v48, v22
v_cvt_f32_i32 v49, v23
buffer_load_dwordx4 v[20:23], v1, s[12:15], s27 offen offset:256 nt
v_pk_fma_f32 v[72:73], v[46:47], v[64:65], v[72:73] op_sel_hi:[1,0,1]
v_pk_fma_f32 v[74:75], v[48:49], v[64:65], v[74:75] op_sel_hi:[1,0,1]
s_waitcnt vmcnt(5)
v_cvt_f32_i32 v42, v24
v_cvt_f32_i32 v43, v25
v_cvt_f32_i32 v44, v26
v_cvt_f32_i32 v45, v27
buffer_load_dwordx4 v[24:27], v1, s[12:15], s27 offen offset:512 nt
v_pk_fma_f32 v[76:77], v[42:43], v[64:65], v[76:77] op_sel_hi:[1,0,1]
v_pk_fma_f32 v[78:79], v[44:45], v[64:65], v[78:79] op_sel_hi:[1,0,1]
s_add_u32 s27, s26, 4718592
v_mov_b32_dpp v64, v112 row_newbcast:10 row_mask:0xf bank_mask:0xf
s_waitcnt vmcnt(5)
v_cvt_f32_i32 v42, v4
v_cvt_f32_i32 v43, v5
v_cvt_f32_i32 v44, v6
v_cvt_f32_i32 v45, v7
buffer_load_dwordx4 v[4:7], v1, s[12:15], s27 offen offset:0 nt
v_pk_fma_f32 v[68:69], v[42:43], v[64:65], v[68:69] op_sel_hi:[1,0,1]
v_pk_fma_f32 v[70:71], v[44:45], v[64:65], v[70:71] op_sel_hi:[1,0,1]
s_waitcnt vmcnt(5)
v_cvt_f32_i32 v46, v8
v_cvt_f32_i32 v47, v9
v_cvt_f32_i32 v48, v10
v_cvt_f32_i32 v49, v11
buffer_load_dwordx4 v[8:11], v1, s[12:15], s27 offen offset:256 nt
v_pk_fma_f32 v[72:73], v[46:47], v[64:65], v[72:73] op_sel_hi:[1,0,1]
v_pk_fma_f32 v[74:75], v[48:49], v[64:65], v[74:75] op_sel_hi:[1,0,1]
s_waitcnt vmcnt(5)
v_cvt_f32_i32 v42, v12
v_cvt_f32_i32 v43, v13
v_cvt_f32_i32 v44, v14
v_cvt_f32_i32 v45, v15
buffer_load_dwordx4 v[12:15], v1, s[12:15], s27 offen offset:512 nt
v_pk_fma_f32 v[76:77], v[42:43], v[64:65], v[76:77] op_sel_hi:[1,0,1]
v_pk_fma_f32 v[78:79], v[44:45], v[64:65], v[78:79] op_sel_hi:[1,0,1]
s_add_u32 s27, s26, 4721664
v_mov_b32_dpp v64, v112 row_newbcast:11 row_mask:0xf bank_mask:0xf
s_waitcnt vmcnt(5)
v_cvt_f32_i32 v42, v16
v_cvt_f32_i32 v43, v17
v_cvt_f32_i32 v44, v18
v_cvt_f32_i32 v45, v19
buffer_load_dwordx4 v[16:19], v1, s[12:15], s27 offen offset:0 nt
v_pk_fma_f32 v[68:69], v[42:43], v[64:65], v[68:69] op_sel_hi:[1,0,1]
v_pk_fma_f32 v[70:71], v[44:45], v[64:65], v[70:71] op_sel_hi:[1,0,1]
s_waitcnt vmcnt(5)
v_cvt_f32_i32 v46, v20
v_cvt_f32_i32 v47, v21
v_cvt_f32_i32 v48, v22
v_cvt_f32_i32 v49, v23
buffer_load_dwordx4 v[20:23], v1, s[12:15], s27 offen offset:256 nt
v_pk_fma_f32 v[72:73], v[46:47], v[64:65], v[72:73] op_sel_hi:[1,0,1]
v_pk_fma_f32 v[74:75], v[48:49], v[64:65], v[74:75] op_sel_hi:[1,0,1]
s_waitcnt vmcnt(5)
v_cvt_f32_i32 v42, v24
v_cvt_f32_i32 v43, v25
v_cvt_f32_i32 v44, v26
v_cvt_f32_i32 v45, v27
buffer_load_dwordx4 v[24:27], v1, s[12:15], s27 offen offset:512 nt
v_pk_fma_f32 v[76:77], v[42:43], v[64:65], v[76:77] op_sel_hi:[1,0,1]
v_pk_fma_f32 v[78:79], v[44:45], v[64:65], v[78:79] op_sel_hi:[1,0,1]
s_add_u32 s27, s26, 4724736
v_mov_b32_dpp v64, v112 row_newbcast:12 row_mask:0xf bank_mask:0xf
s_waitcnt vmcnt(5)
v_cvt_f32_i32 v42, v4
v_cvt_f32_i32 v43, v5
v_cvt_f32_i32 v44, v6
v_cvt_f32_i32 v45, v7
buffer_load_dwordx4 v[4:7], v1, s[12:15], s27 offen offset:0 nt
v_pk_fma_f32 v[68:69], v[42:43], v[64:65], v[68:69] op_sel_hi:[1,0,1]
v_pk_fma_f32 v[70:71], v[44:45], v[64:65], v[70:71] op_sel_hi:[1,0,1]
s_waitcnt vmcnt(5)
v_cvt_f32_i32 v46, v8
v_cvt_f32_i32 v47, v9
v_cvt_f32_i32 v48, v10
v_cvt_f32_i32 v49, v11
buffer_load_dwordx4 v[8:11], v1, s[12:15], s27 offen offset:256 nt
v_pk_fma_f32 v[72:73], v[46:47], v[64:65], v[72:73] op_sel_hi:[1,0,1]
v_pk_fma_f32 v[74:75], v[48:49], v[64:65], v[74:75] op_sel_hi:[1,0,1]
s_waitcnt vmcnt(5)
v_cvt_f32_i32 v42, v12
v_cvt_f32_i32 v43, v13
v_cvt_f32_i32 v44, v14
v_cvt_f32_i32 v45, v15
buffer_load_dwordx4 v[12:15], v1, s[12:15], s27 offen offset:512 nt
v_pk_fma_f32 v[76:77], v[42:43], v[64:65], v[76:77] op_sel_hi:[1,0,1]
v_pk_fma_f32 v[78:79], v[44:45], v[64:65], v[78:79] op_sel_hi:[1,0,1]
s_add_u32 s27, s26, 4727808
v_mov_b32_dpp v64, v112 row_newbcast:13 row_mask:0xf bank_mask:0xf
s_waitcnt vmcnt(5)
v_cvt_f32_i32 v42, v16
v_cvt_f32_i32 v43, v17
v_cvt_f32_i32 v44, v18
v_cvt_f32_i32 v45, v19
buffer_load_dwordx4 v[16:19], v1, s[12:15], s27 offen offset:0 nt
v_pk_fma_f32 v[68:69], v[42:43], v[64:65], v[68:69] op_sel_hi:[1,0,1]
v_pk_fma_f32 v[70:71], v[44:45], v[64:65], v[70:71] op_sel_hi:[1,0,1]
s_waitcnt vmcnt(5)
v_cvt_f32_i32 v46, v20
v_cvt_f32_i32 v47, v21
v_cvt_f32_i32 v48, v22
v_cvt_f32_i32 v49, v23
buffer_load_dwordx4 v[20:23], v1, s[12:15], s27 offen offset:256 nt
v_pk_fma_f32 v[72:73], v[46:47], v[64:65], v[72:73] op_sel_hi:[1,0,1]
v_pk_fma_f32 v[74:75], v[48:49], v[64:65], v[74:75] op_sel_hi:[1,0,1]
s_waitcnt vmcnt(5)
v_cvt_f32_i32 v42, v24
v_cvt_f32_i32 v43, v25
v_cvt_f32_i32 v44, v26
v_cvt_f32_i32 v45, v27
buffer_load_dwordx4 v[24:27], v1, s[12:15], s27 offen offset:512 nt
v_pk_fma_f32 v[76:77], v[42:43], v[64:65], v[76:77] op_sel_hi:[1,0,1]
v_pk_fma_f32 v[78:79], v[44:45], v[64:65], v[78:79] op_sel_hi:[1,0,1]
s_mov_b32 s27, s57
v_mov_b32_dpp v64, v112 row_newbcast:14 row_mask:0xf bank_mask:0xf
s_waitcnt vmcnt(5)
v_cvt_f32_i32 v42, v4
v_cvt_f32_i32 v43, v5
v_cvt_f32_i32 v44, v6
v_cvt_f32_i32 v45, v7
buffer_load_dwordx4 v[4:7], v1, s[12:15], s27 offen offset:0 nt
v_pk_fma_f32 v[68:69], v[42:43], v[64:65], v[68:69] op_sel_hi:[1,0,1]
v_pk_fma_f32 v[70:71], v[44:45], v[64:65], v[70:71] op_sel_hi:[1,0,1]
s_waitcnt vmcnt(5)
v_cvt_f32_i32 v46, v8
v_cvt_f32_i32 v47, v9
v_cvt_f32_i32 v48, v10
v_cvt_f32_i32 v49, v11
buffer_load_dwordx4 v[8:11], v1, s[12:15], s27 offen offset:256 nt
v_pk_fma_f32 v[72:73], v[46:47], v[64:65], v[72:73] op_sel_hi:[1,0,1]
v_pk_fma_f32 v[74:75], v[48:49], v[64:65], v[74:75] op_sel_hi:[1,0,1]
s_waitcnt vmcnt(5)
v_cvt_f32_i32 v42, v12
v_cvt_f32_i32 v43, v13
v_cvt_f32_i32 v44, v14
v_cvt_f32_i32 v45, v15
buffer_load_dwordx4 v[12:15], v1, s[12:15], s27 offen offset:512 nt
v_pk_fma_f32 v[76:77], v[42:43], v[64:65], v[76:77] op_sel_hi:[1,0,1]
v_pk_fma_f32 v[78:79], v[44:45], v[64:65], v[78:79] op_sel_hi:[1,0,1]
s_add_u32 s27, s57, 3072
v_mov_b32_dpp v64, v112 row_newbcast:15 row_mask:0xf bank_mask:0xf
s_waitcnt vmcnt(5)
v_cvt_f32_i32 v42, v16
v_cvt_f32_i32 v43, v17
v_cvt_f32_i32 v44, v18
v_cvt_f32_i32 v45, v19
buffer_load_dwordx4 v[16:19], v1, s[12:15], s27 offen offset:0 nt
v_pk_fma_f32 v[68:69], v[42:43], v[64:65], v[68:69] op_sel_hi:[1,0,1]
v_pk_fma_f32 v[70:71], v[44:45], v[64:65], v[70:71] op_sel_hi:[1,0,1]
s_waitcnt vmcnt(5)
v_cvt_f32_i32 v46, v20
v_cvt_f32_i32 v47, v21
v_cvt_f32_i32 v48, v22
v_cvt_f32_i32 v49, v23
buffer_load_dwordx4 v[20:23], v1, s[12:15], s27 offen offset:256 nt
v_pk_fma_f32 v[72:73], v[46:47], v[64:65], v[72:73] op_sel_hi:[1,0,1]
v_pk_fma_f32 v[74:75], v[48:49], v[64:65], v[74:75] op_sel_hi:[1,0,1]
s_waitcnt vmcnt(5)
v_cvt_f32_i32 v42, v24
v_cvt_f32_i32 v43, v25
v_cvt_f32_i32 v44, v26
v_cvt_f32_i32 v45, v27
buffer_load_dwordx4 v[24:27], v1, s[12:15], s27 offen offset:512 nt
v_pk_fma_f32 v[76:77], v[42:43], v[64:65], v[76:77] op_sel_hi:[1,0,1]
v_pk_fma_f32 v[78:79], v[44:45], v[64:65], v[78:79] op_sel_hi:[1,0,1]
v_mov_b32 v112, v113
v_mov_b32 v113, v114
v_mov_b32 v114, v115
v_mov_b32 v115, v116
v_mov_b32 v116, v117
v_mov_b32 v117, v118
v_mov_b32 v118, v119
v_mov_b32 v119, v120
v_mov_b32 v120, v121
v_mov_b32 v121, v122
v_mov_b32 v122, v123
v_mov_b32 v123, v124
v_mov_b32 v124, v125
v_mov_b32 v125, v126
v_mov_b32 v126, v127
s_mov_b32 s26, s57
s_add_u32 s29, s29, 1
s_and_b32 s4, s29, 3
s_cbranch_scc1 L_vblk_standalone__kv_cache_quant_int4_int2_kv_with_per_channel_or_per_token_scales__decode_kernel
s_branch L_flush_standalone__kv_cache_quant_int4_int2_kv_with_per_channel_or_per_token_scales__decode_kernel
L_deep_standalone__kv_cache_quant_int4_int2_kv_with_per_channel_or_per_token_scales__decode_kernel:
s_add_u32 s27, s26, 6144
buffer_load_dwordx4 v[160:163], v1, s[12:15], s27 offen offset:0 nt
buffer_load_dwordx4 v[164:167], v1, s[12:15], s27 offen offset:256 nt
buffer_load_dwordx4 v[168:171], v1, s[12:15], s27 offen offset:512 nt
s_add_u32 s27, s26, 9216
buffer_load_dwordx4 v[172:175], v1, s[12:15], s27 offen offset:0 nt
buffer_load_dwordx4 v[176:179], v1, s[12:15], s27 offen offset:256 nt
buffer_load_dwordx4 v[180:183], v1, s[12:15], s27 offen offset:512 nt
L_dblk_standalone__kv_cache_quant_int4_int2_kv_with_per_channel_or_per_token_scales__decode_kernel:
s_add_u32 s27, s26, 1572864
v_mov_b32_dpp v64, v112 row_newbcast:0 row_mask:0xf bank_mask:0xf
s_waitcnt vmcnt(11)
v_cvt_f32_i32 v42, v4
v_cvt_f32_i32 v43, v5
v_cvt_f32_i32 v44, v6
v_cvt_f32_i32 v45, v7
buffer_load_dwordx4 v[4:7], v1, s[12:15], s27 offen offset:0 nt
v_pk_fma_f32 v[68:69], v[42:43], v[64:65], v[68:69] op_sel_hi:[1,0,1]
v_pk_fma_f32 v[70:71], v[44:45], v[64:65], v[70:71] op_sel_hi:[1,0,1]
s_waitcnt vmcnt(11)
v_cvt_f32_i32 v46, v8
v_cvt_f32_i32 v47, v9
v_cvt_f32_i32 v48, v10
v_cvt_f32_i32 v49, v11
buffer_load_dwordx4 v[8:11], v1, s[12:15], s27 offen offset:256 nt
v_pk_fma_f32 v[72:73], v[46:47], v[64:65], v[72:73] op_sel_hi:[1,0,1]
v_pk_fma_f32 v[74:75], v[48:49], v[64:65], v[74:75] op_sel_hi:[1,0,1]
s_waitcnt vmcnt(11)
v_cvt_f32_i32 v42, v12
v_cvt_f32_i32 v43, v13
v_cvt_f32_i32 v44, v14
v_cvt_f32_i32 v45, v15
buffer_load_dwordx4 v[12:15], v1, s[12:15], s27 offen offset:512 nt
v_pk_fma_f32 v[76:77], v[42:43], v[64:65], v[76:77] op_sel_hi:[1,0,1]
v_pk_fma_f32 v[78:79], v[44:45], v[64:65], v[78:79] op_sel_hi:[1,0,1]
s_add_u32 s27, s26, 1575936
v_mov_b32_dpp v64, v112 row_newbcast:1 row_mask:0xf bank_mask:0xf
s_waitcnt vmcnt(11)
v_cvt_f32_i32 v42, v16
v_cvt_f32_i32 v43, v17
v_cvt_f32_i32 v44, v18
v_cvt_f32_i32 v45, v19
buffer_load_dwordx4 v[16:19], v1, s[12:15], s27 offen offset:0 nt
v_pk_fma_f32 v[68:69], v[42:43], v[64:65], v[68:69] op_sel_hi:[1,0,1]
v_pk_fma_f32 v[70:71], v[44:45], v[64:65], v[70:71] op_sel_hi:[1,0,1]
s_waitcnt vmcnt(11)
v_cvt_f32_i32 v46, v20
v_cvt_f32_i32 v47, v21
v_cvt_f32_i32 v48, v22
v_cvt_f32_i32 v49, v23
buffer_load_dwordx4 v[20:23], v1, s[12:15], s27 offen offset:256 nt
v_pk_fma_f32 v[72:73], v[46:47], v[64:65], v[72:73] op_sel_hi:[1,0,1]
v_pk_fma_f32 v[74:75], v[48:49], v[64:65], v[74:75] op_sel_hi:[1,0,1]
s_waitcnt vmcnt(11)
v_cvt_f32_i32 v42, v24
v_cvt_f32_i32 v43, v25
v_cvt_f32_i32 v44, v26
v_cvt_f32_i32 v45, v27
buffer_load_dwordx4 v[24:27], v1, s[12:15], s27 offen offset:512 nt
v_pk_fma_f32 v[76:77], v[42:43], v[64:65], v[76:77] op_sel_hi:[1,0,1]
v_pk_fma_f32 v[78:79], v[44:45], v[64:65], v[78:79] op_sel_hi:[1,0,1]
s_add_u32 s27, s26, 1579008
v_mov_b32_dpp v64, v112 row_newbcast:2 row_mask:0xf bank_mask:0xf
s_waitcnt vmcnt(11)
v_cvt_f32_i32 v42, v160
v_cvt_f32_i32 v43, v161
v_cvt_f32_i32 v44, v162
v_cvt_f32_i32 v45, v163
buffer_load_dwordx4 v[160:163], v1, s[12:15], s27 offen offset:0 nt
v_pk_fma_f32 v[68:69], v[42:43], v[64:65], v[68:69] op_sel_hi:[1,0,1]
v_pk_fma_f32 v[70:71], v[44:45], v[64:65], v[70:71] op_sel_hi:[1,0,1]
s_waitcnt vmcnt(11)
v_cvt_f32_i32 v46, v164
v_cvt_f32_i32 v47, v165
v_cvt_f32_i32 v48, v166
v_cvt_f32_i32 v49, v167
buffer_load_dwordx4 v[164:167], v1, s[12:15], s27 offen offset:256 nt
v_pk_fma_f32 v[72:73], v[46:47], v[64:65], v[72:73] op_sel_hi:[1,0,1]
v_pk_fma_f32 v[74:75], v[48:49], v[64:65], v[74:75] op_sel_hi:[1,0,1]
s_waitcnt vmcnt(11)
v_cvt_f32_i32 v42, v168
v_cvt_f32_i32 v43, v169
v_cvt_f32_i32 v44, v170
v_cvt_f32_i32 v45, v171
buffer_load_dwordx4 v[168:171], v1, s[12:15], s27 offen offset:512 nt
v_pk_fma_f32 v[76:77], v[42:43], v[64:65], v[76:77] op_sel_hi:[1,0,1]
v_pk_fma_f32 v[78:79], v[44:45], v[64:65], v[78:79] op_sel_hi:[1,0,1]
s_add_u32 s27, s26, 1582080
v_mov_b32_dpp v64, v112 row_newbcast:3 row_mask:0xf bank_mask:0xf
s_waitcnt vmcnt(11)
v_cvt_f32_i32 v42, v172
v_cvt_f32_i32 v43, v173
v_cvt_f32_i32 v44, v174
v_cvt_f32_i32 v45, v175
buffer_load_dwordx4 v[172:175], v1, s[12:15], s27 offen offset:0 nt
v_pk_fma_f32 v[68:69], v[42:43], v[64:65], v[68:69] op_sel_hi:[1,0,1]
v_pk_fma_f32 v[70:71], v[44:45], v[64:65], v[70:71] op_sel_hi:[1,0,1]
s_waitcnt vmcnt(11)
v_cvt_f32_i32 v46, v176
v_cvt_f32_i32 v47, v177
v_cvt_f32_i32 v48, v178
v_cvt_f32_i32 v49, v179
buffer_load_dwordx4 v[176:179], v1, s[12:15], s27 offen offset:256 nt
v_pk_fma_f32 v[72:73], v[46:47], v[64:65], v[72:73] op_sel_hi:[1,0,1]
v_pk_fma_f32 v[74:75], v[48:49], v[64:65], v[74:75] op_sel_hi:[1,0,1]
s_waitcnt vmcnt(11)
v_cvt_f32_i32 v42, v180
v_cvt_f32_i32 v43, v181
v_cvt_f32_i32 v44, v182
v_cvt_f32_i32 v45, v183
buffer_load_dwordx4 v[180:183], v1, s[12:15], s27 offen offset:512 nt
v_pk_fma_f32 v[76:77], v[42:43], v[64:65], v[76:77] op_sel_hi:[1,0,1]
v_pk_fma_f32 v[78:79], v[44:45], v[64:65], v[78:79] op_sel_hi:[1,0,1]
s_add_u32 s27, s26, 3145728
v_mov_b32_dpp v64, v112 row_newbcast:4 row_mask:0xf bank_mask:0xf
s_waitcnt vmcnt(11)
v_cvt_f32_i32 v42, v4
v_cvt_f32_i32 v43, v5
v_cvt_f32_i32 v44, v6
v_cvt_f32_i32 v45, v7
buffer_load_dwordx4 v[4:7], v1, s[12:15], s27 offen offset:0 nt
v_pk_fma_f32 v[68:69], v[42:43], v[64:65], v[68:69] op_sel_hi:[1,0,1]
v_pk_fma_f32 v[70:71], v[44:45], v[64:65], v[70:71] op_sel_hi:[1,0,1]
s_waitcnt vmcnt(11)
v_cvt_f32_i32 v46, v8
v_cvt_f32_i32 v47, v9
v_cvt_f32_i32 v48, v10
v_cvt_f32_i32 v49, v11
buffer_load_dwordx4 v[8:11], v1, s[12:15], s27 offen offset:256 nt
v_pk_fma_f32 v[72:73], v[46:47], v[64:65], v[72:73] op_sel_hi:[1,0,1]
v_pk_fma_f32 v[74:75], v[48:49], v[64:65], v[74:75] op_sel_hi:[1,0,1]
s_waitcnt vmcnt(11)
v_cvt_f32_i32 v42, v12
v_cvt_f32_i32 v43, v13
v_cvt_f32_i32 v44, v14
v_cvt_f32_i32 v45, v15
buffer_load_dwordx4 v[12:15], v1, s[12:15], s27 offen offset:512 nt
v_pk_fma_f32 v[76:77], v[42:43], v[64:65], v[76:77] op_sel_hi:[1,0,1]
v_pk_fma_f32 v[78:79], v[44:45], v[64:65], v[78:79] op_sel_hi:[1,0,1]
s_add_u32 s27, s26, 3148800
v_mov_b32_dpp v64, v112 row_newbcast:5 row_mask:0xf bank_mask:0xf
s_waitcnt vmcnt(11)
v_cvt_f32_i32 v42, v16
v_cvt_f32_i32 v43, v17
v_cvt_f32_i32 v44, v18
v_cvt_f32_i32 v45, v19
buffer_load_dwordx4 v[16:19], v1, s[12:15], s27 offen offset:0 nt
v_pk_fma_f32 v[68:69], v[42:43], v[64:65], v[68:69] op_sel_hi:[1,0,1]
v_pk_fma_f32 v[70:71], v[44:45], v[64:65], v[70:71] op_sel_hi:[1,0,1]
s_waitcnt vmcnt(11)
v_cvt_f32_i32 v46, v20
v_cvt_f32_i32 v47, v21
v_cvt_f32_i32 v48, v22
v_cvt_f32_i32 v49, v23
buffer_load_dwordx4 v[20:23], v1, s[12:15], s27 offen offset:256 nt
v_pk_fma_f32 v[72:73], v[46:47], v[64:65], v[72:73] op_sel_hi:[1,0,1]
v_pk_fma_f32 v[74:75], v[48:49], v[64:65], v[74:75] op_sel_hi:[1,0,1]
s_waitcnt vmcnt(11)
v_cvt_f32_i32 v42, v24
v_cvt_f32_i32 v43, v25
v_cvt_f32_i32 v44, v26
v_cvt_f32_i32 v45, v27
buffer_load_dwordx4 v[24:27], v1, s[12:15], s27 offen offset:512 nt
v_pk_fma_f32 v[76:77], v[42:43], v[64:65], v[76:77] op_sel_hi:[1,0,1]
v_pk_fma_f32 v[78:79], v[44:45], v[64:65], v[78:79] op_sel_hi:[1,0,1]
s_add_u32 s27, s26, 3151872
v_mov_b32_dpp v64, v112 row_newbcast:6 row_mask:0xf bank_mask:0xf
s_waitcnt vmcnt(11)
v_cvt_f32_i32 v42, v160
v_cvt_f32_i32 v43, v161
v_cvt_f32_i32 v44, v162
v_cvt_f32_i32 v45, v163
buffer_load_dwordx4 v[160:163], v1, s[12:15], s27 offen offset:0 nt
v_pk_fma_f32 v[68:69], v[42:43], v[64:65], v[68:69] op_sel_hi:[1,0,1]
v_pk_fma_f32 v[70:71], v[44:45], v[64:65], v[70:71] op_sel_hi:[1,0,1]
s_waitcnt vmcnt(11)
v_cvt_f32_i32 v46, v164
v_cvt_f32_i32 v47, v165
v_cvt_f32_i32 v48, v166
v_cvt_f32_i32 v49, v167
buffer_load_dwordx4 v[164:167], v1, s[12:15], s27 offen offset:256 nt
v_pk_fma_f32 v[72:73], v[46:47], v[64:65], v[72:73] op_sel_hi:[1,0,1]
v_pk_fma_f32 v[74:75], v[48:49], v[64:65], v[74:75] op_sel_hi:[1,0,1]
s_waitcnt vmcnt(11)
v_cvt_f32_i32 v42, v168
v_cvt_f32_i32 v43, v169
v_cvt_f32_i32 v44, v170
v_cvt_f32_i32 v45, v171
buffer_load_dwordx4 v[168:171], v1, s[12:15], s27 offen offset:512 nt
v_pk_fma_f32 v[76:77], v[42:43], v[64:65], v[76:77] op_sel_hi:[1,0,1]
v_pk_fma_f32 v[78:79], v[44:45], v[64:65], v[78:79] op_sel_hi:[1,0,1]
s_add_u32 s27, s26, 3154944
v_mov_b32_dpp v64, v112 row_newbcast:7 row_mask:0xf bank_mask:0xf
s_waitcnt vmcnt(11)
v_cvt_f32_i32 v42, v172
v_cvt_f32_i32 v43, v173
v_cvt_f32_i32 v44, v174
v_cvt_f32_i32 v45, v175
buffer_load_dwordx4 v[172:175], v1, s[12:15], s27 offen offset:0 nt
v_pk_fma_f32 v[68:69], v[42:43], v[64:65], v[68:69] op_sel_hi:[1,0,1]
v_pk_fma_f32 v[70:71], v[44:45], v[64:65], v[70:71] op_sel_hi:[1,0,1]
s_waitcnt vmcnt(11)
v_cvt_f32_i32 v46, v176
v_cvt_f32_i32 v47, v177
v_cvt_f32_i32 v48, v178
v_cvt_f32_i32 v49, v179
buffer_load_dwordx4 v[176:179], v1, s[12:15], s27 offen offset:256 nt
v_pk_fma_f32 v[72:73], v[46:47], v[64:65], v[72:73] op_sel_hi:[1,0,1]
v_pk_fma_f32 v[74:75], v[48:49], v[64:65], v[74:75] op_sel_hi:[1,0,1]
s_waitcnt vmcnt(11)
v_cvt_f32_i32 v42, v180
v_cvt_f32_i32 v43, v181
v_cvt_f32_i32 v44, v182
v_cvt_f32_i32 v45, v183
buffer_load_dwordx4 v[180:183], v1, s[12:15], s27 offen offset:512 nt
v_pk_fma_f32 v[76:77], v[42:43], v[64:65], v[76:77] op_sel_hi:[1,0,1]
v_pk_fma_f32 v[78:79], v[44:45], v[64:65], v[78:79] op_sel_hi:[1,0,1]
s_add_u32 s27, s26, 4718592
v_mov_b32_dpp v64, v112 row_newbcast:8 row_mask:0xf bank_mask:0xf
s_waitcnt vmcnt(11)
v_cvt_f32_i32 v42, v4
v_cvt_f32_i32 v43, v5
v_cvt_f32_i32 v44, v6
v_cvt_f32_i32 v45, v7
buffer_load_dwordx4 v[4:7], v1, s[12:15], s27 offen offset:0 nt
v_pk_fma_f32 v[68:69], v[42:43], v[64:65], v[68:69] op_sel_hi:[1,0,1]
v_pk_fma_f32 v[70:71], v[44:45], v[64:65], v[70:71] op_sel_hi:[1,0,1]
s_waitcnt vmcnt(11)
v_cvt_f32_i32 v46, v8
v_cvt_f32_i32 v47, v9
v_cvt_f32_i32 v48, v10
v_cvt_f32_i32 v49, v11
buffer_load_dwordx4 v[8:11], v1, s[12:15], s27 offen offset:256 nt
v_pk_fma_f32 v[72:73], v[46:47], v[64:65], v[72:73] op_sel_hi:[1,0,1]
v_pk_fma_f32 v[74:75], v[48:49], v[64:65], v[74:75] op_sel_hi:[1,0,1]
s_waitcnt vmcnt(11)
v_cvt_f32_i32 v42, v12
v_cvt_f32_i32 v43, v13
v_cvt_f32_i32 v44, v14
v_cvt_f32_i32 v45, v15
buffer_load_dwordx4 v[12:15], v1, s[12:15], s27 offen offset:512 nt
v_pk_fma_f32 v[76:77], v[42:43], v[64:65], v[76:77] op_sel_hi:[1,0,1]
v_pk_fma_f32 v[78:79], v[44:45], v[64:65], v[78:79] op_sel_hi:[1,0,1]
s_add_u32 s27, s26, 4721664
v_mov_b32_dpp v64, v112 row_newbcast:9 row_mask:0xf bank_mask:0xf
s_waitcnt vmcnt(11)
v_cvt_f32_i32 v42, v16
v_cvt_f32_i32 v43, v17
v_cvt_f32_i32 v44, v18
v_cvt_f32_i32 v45, v19
buffer_load_dwordx4 v[16:19], v1, s[12:15], s27 offen offset:0 nt
v_pk_fma_f32 v[68:69], v[42:43], v[64:65], v[68:69] op_sel_hi:[1,0,1]
v_pk_fma_f32 v[70:71], v[44:45], v[64:65], v[70:71] op_sel_hi:[1,0,1]
s_waitcnt vmcnt(11)
v_cvt_f32_i32 v46, v20
v_cvt_f32_i32 v47, v21
v_cvt_f32_i32 v48, v22
v_cvt_f32_i32 v49, v23
buffer_load_dwordx4 v[20:23], v1, s[12:15], s27 offen offset:256 nt
v_pk_fma_f32 v[72:73], v[46:47], v[64:65], v[72:73] op_sel_hi:[1,0,1]
v_pk_fma_f32 v[74:75], v[48:49], v[64:65], v[74:75] op_sel_hi:[1,0,1]
s_waitcnt vmcnt(11)
v_cvt_f32_i32 v42, v24
v_cvt_f32_i32 v43, v25
v_cvt_f32_i32 v44, v26
v_cvt_f32_i32 v45, v27
buffer_load_dwordx4 v[24:27], v1, s[12:15], s27 offen offset:512 nt
v_pk_fma_f32 v[76:77], v[42:43], v[64:65], v[76:77] op_sel_hi:[1,0,1]
v_pk_fma_f32 v[78:79], v[44:45], v[64:65], v[78:79] op_sel_hi:[1,0,1]
s_add_u32 s27, s26, 4724736
v_mov_b32_dpp v64, v112 row_newbcast:10 row_mask:0xf bank_mask:0xf
s_waitcnt vmcnt(11)
v_cvt_f32_i32 v42, v160
v_cvt_f32_i32 v43, v161
v_cvt_f32_i32 v44, v162
v_cvt_f32_i32 v45, v163
buffer_load_dwordx4 v[160:163], v1, s[12:15], s27 offen offset:0 nt
v_pk_fma_f32 v[68:69], v[42:43], v[64:65], v[68:69] op_sel_hi:[1,0,1]
v_pk_fma_f32 v[70:71], v[44:45], v[64:65], v[70:71] op_sel_hi:[1,0,1]
s_waitcnt vmcnt(11)
v_cvt_f32_i32 v46, v164
v_cvt_f32_i32 v47, v165
v_cvt_f32_i32 v48, v166
v_cvt_f32_i32 v49, v167
buffer_load_dwordx4 v[164:167], v1, s[12:15], s27 offen offset:256 nt
v_pk_fma_f32 v[72:73], v[46:47], v[64:65], v[72:73] op_sel_hi:[1,0,1]
v_pk_fma_f32 v[74:75], v[48:49], v[64:65], v[74:75] op_sel_hi:[1,0,1]
s_waitcnt vmcnt(11)
v_cvt_f32_i32 v42, v168
v_cvt_f32_i32 v43, v169
v_cvt_f32_i32 v44, v170
v_cvt_f32_i32 v45, v171
buffer_load_dwordx4 v[168:171], v1, s[12:15], s27 offen offset:512 nt
v_pk_fma_f32 v[76:77], v[42:43], v[64:65], v[76:77] op_sel_hi:[1,0,1]
v_pk_fma_f32 v[78:79], v[44:45], v[64:65], v[78:79] op_sel_hi:[1,0,1]
s_add_u32 s27, s26, 4727808
v_mov_b32_dpp v64, v112 row_newbcast:11 row_mask:0xf bank_mask:0xf
s_waitcnt vmcnt(11)
v_cvt_f32_i32 v42, v172
v_cvt_f32_i32 v43, v173
v_cvt_f32_i32 v44, v174
v_cvt_f32_i32 v45, v175
buffer_load_dwordx4 v[172:175], v1, s[12:15], s27 offen offset:0 nt
v_pk_fma_f32 v[68:69], v[42:43], v[64:65], v[68:69] op_sel_hi:[1,0,1]
v_pk_fma_f32 v[70:71], v[44:45], v[64:65], v[70:71] op_sel_hi:[1,0,1]
s_waitcnt vmcnt(11)
v_cvt_f32_i32 v46, v176
v_cvt_f32_i32 v47, v177
v_cvt_f32_i32 v48, v178
v_cvt_f32_i32 v49, v179
buffer_load_dwordx4 v[176:179], v1, s[12:15], s27 offen offset:256 nt
v_pk_fma_f32 v[72:73], v[46:47], v[64:65], v[72:73] op_sel_hi:[1,0,1]
v_pk_fma_f32 v[74:75], v[48:49], v[64:65], v[74:75] op_sel_hi:[1,0,1]
s_waitcnt vmcnt(11)
v_cvt_f32_i32 v42, v180
v_cvt_f32_i32 v43, v181
v_cvt_f32_i32 v44, v182
v_cvt_f32_i32 v45, v183
buffer_load_dwordx4 v[180:183], v1, s[12:15], s27 offen offset:512 nt
v_pk_fma_f32 v[76:77], v[42:43], v[64:65], v[76:77] op_sel_hi:[1,0,1]
v_pk_fma_f32 v[78:79], v[44:45], v[64:65], v[78:79] op_sel_hi:[1,0,1]
v_mov_b32_dpp v64, v112 row_newbcast:12 row_mask:0xf bank_mask:0xf
s_waitcnt vmcnt(11)
v_cvt_f32_i32 v42, v4
v_cvt_f32_i32 v43, v5
v_cvt_f32_i32 v44, v6
v_cvt_f32_i32 v45, v7
v_pk_fma_f32 v[68:69], v[42:43], v[64:65], v[68:69] op_sel_hi:[1,0,1]
v_pk_fma_f32 v[70:71], v[44:45], v[64:65], v[70:71] op_sel_hi:[1,0,1]
s_waitcnt vmcnt(10)
v_cvt_f32_i32 v46, v8
v_cvt_f32_i32 v47, v9
v_cvt_f32_i32 v48, v10
v_cvt_f32_i32 v49, v11
v_pk_fma_f32 v[72:73], v[46:47], v[64:65], v[72:73] op_sel_hi:[1,0,1]
v_pk_fma_f32 v[74:75], v[48:49], v[64:65], v[74:75] op_sel_hi:[1,0,1]
s_waitcnt vmcnt(9)
v_cvt_f32_i32 v42, v12
v_cvt_f32_i32 v43, v13
v_cvt_f32_i32 v44, v14
v_cvt_f32_i32 v45, v15
v_pk_fma_f32 v[76:77], v[42:43], v[64:65], v[76:77] op_sel_hi:[1,0,1]
v_pk_fma_f32 v[78:79], v[44:45], v[64:65], v[78:79] op_sel_hi:[1,0,1]
v_mov_b32_dpp v64, v112 row_newbcast:13 row_mask:0xf bank_mask:0xf
s_waitcnt vmcnt(8)
v_cvt_f32_i32 v42, v16
v_cvt_f32_i32 v43, v17
v_cvt_f32_i32 v44, v18
v_cvt_f32_i32 v45, v19
v_pk_fma_f32 v[68:69], v[42:43], v[64:65], v[68:69] op_sel_hi:[1,0,1]
v_pk_fma_f32 v[70:71], v[44:45], v[64:65], v[70:71] op_sel_hi:[1,0,1]
s_waitcnt vmcnt(7)
v_cvt_f32_i32 v46, v20
v_cvt_f32_i32 v47, v21
v_cvt_f32_i32 v48, v22
v_cvt_f32_i32 v49, v23
v_pk_fma_f32 v[72:73], v[46:47], v[64:65], v[72:73] op_sel_hi:[1,0,1]
v_pk_fma_f32 v[74:75], v[48:49], v[64:65], v[74:75] op_sel_hi:[1,0,1]
s_waitcnt vmcnt(6)
v_cvt_f32_i32 v42, v24
v_cvt_f32_i32 v43, v25
v_cvt_f32_i32 v44, v26
v_cvt_f32_i32 v45, v27
v_pk_fma_f32 v[76:77], v[42:43], v[64:65], v[76:77] op_sel_hi:[1,0,1]
v_pk_fma_f32 v[78:79], v[44:45], v[64:65], v[78:79] op_sel_hi:[1,0,1]
v_mov_b32_dpp v64, v112 row_newbcast:14 row_mask:0xf bank_mask:0xf
s_waitcnt vmcnt(5)
v_cvt_f32_i32 v42, v160
v_cvt_f32_i32 v43, v161
v_cvt_f32_i32 v44, v162
v_cvt_f32_i32 v45, v163
v_pk_fma_f32 v[68:69], v[42:43], v[64:65], v[68:69] op_sel_hi:[1,0,1]
v_pk_fma_f32 v[70:71], v[44:45], v[64:65], v[70:71] op_sel_hi:[1,0,1]
s_waitcnt vmcnt(4)
v_cvt_f32_i32 v46, v164
v_cvt_f32_i32 v47, v165
v_cvt_f32_i32 v48, v166
v_cvt_f32_i32 v49, v167
v_pk_fma_f32 v[72:73], v[46:47], v[64:65], v[72:73] op_sel_hi:[1,0,1]
v_pk_fma_f32 v[74:75], v[48:49], v[64:65], v[74:75] op_sel_hi:[1,0,1]
s_waitcnt vmcnt(3)
v_cvt_f32_i32 v42, v168
v_cvt_f32_i32 v43, v169
v_cvt_f32_i32 v44, v170
v_cvt_f32_i32 v45, v171
v_pk_fma_f32 v[76:77], v[42:43], v[64:65], v[76:77] op_sel_hi:[1,0,1]
v_pk_fma_f32 v[78:79], v[44:45], v[64:65], v[78:79] op_sel_hi:[1,0,1]
v_mov_b32_dpp v64, v112 row_newbcast:15 row_mask:0xf bank_mask:0xf
s_waitcnt vmcnt(2)
v_cvt_f32_i32 v42, v172
v_cvt_f32_i32 v43, v173
v_cvt_f32_i32 v44, v174
v_cvt_f32_i32 v45, v175
v_pk_fma_f32 v[68:69], v[42:43], v[64:65], v[68:69] op_sel_hi:[1,0,1]
v_pk_fma_f32 v[70:71], v[44:45], v[64:65], v[70:71] op_sel_hi:[1,0,1]
s_waitcnt vmcnt(1)
v_cvt_f32_i32 v46, v176
v_cvt_f32_i32 v47, v177
v_cvt_f32_i32 v48, v178
v_cvt_f32_i32 v49, v179
v_pk_fma_f32 v[72:73], v[46:47], v[64:65], v[72:73] op_sel_hi:[1,0,1]
v_pk_fma_f32 v[74:75], v[48:49], v[64:65], v[74:75] op_sel_hi:[1,0,1]
s_waitcnt vmcnt(0)
v_cvt_f32_i32 v42, v180
v_cvt_f32_i32 v43, v181
v_cvt_f32_i32 v44, v182
v_cvt_f32_i32 v45, v183
v_pk_fma_f32 v[76:77], v[42:43], v[64:65], v[76:77] op_sel_hi:[1,0,1]
v_pk_fma_f32 v[78:79], v[44:45], v[64:65], v[78:79] op_sel_hi:[1,0,1]
s_add_u32 s29, s29, 1
L_flush_standalone__kv_cache_quant_int4_int2_kv_with_per_channel_or_per_token_scales__decode_kernel:
v_add_u32 v84, s31, v103
s_nop 0
v_permlane32_swap_b32 v68, v70
v_permlane32_swap_b32 v69, v71
v_permlane32_swap_b32 v72, v74
v_permlane32_swap_b32 v73, v75
v_permlane32_swap_b32 v76, v78
v_permlane32_swap_b32 v77, v79
s_nop 1
v_pk_add_f32 v[68:69], v[68:69], v[70:71]
v_pk_add_f32 v[72:73], v[72:73], v[74:75]
v_pk_add_f32 v[76:77], v[76:77], v[78:79]
s_nop 1
v_permlane16_swap_b32 v68, v69
v_permlane16_swap_b32 v72, v73
v_permlane16_swap_b32 v76, v77
s_nop 1
v_add_f32 v88, v68, v69
v_add_f32 v89, v72, v73
v_add_f32 v90, v76, v77
ds_write_b32 v84, v88 offset:0
ds_write_b32 v84, v89 offset:256
ds_write_b32 v84, v90 offset:512
s_add_u32 s31, s31, 3200
s_cmp_lt_u32 s29, 16
s_cbranch_scc1 L_vhead_standalone__kv_cache_quant_int4_int2_kv_with_per_channel_or_per_token_scales__decode_kernel
L_tail_standalone__kv_cache_quant_int4_int2_kv_with_per_channel_or_per_token_scales__decode_kernel:
s_waitcnt lgkmcnt(0)
s_barrier
s_lshl_b32 s4, s24, 2
s_add_u32 s4, s4, s3
s_lshl_b32 s4, s4, 2
v_mov_b32 v60, s4
v_mov_b32 v61, 1
s_mov_b64 exec, 1
global_atomic_add v62, v60, v61, s[48:49] sc0
s_mov_b64 exec, -1
s_mul_i32 s4, s3, 3200
s_add_u32 s4, s4, 12288
v_mov_b32 v84, s4
v_add_u32 v85, s4, v105
s_mul_i32 s5, s24, 4
s_add_u32 s5, s5, s3
s_mul_i32 s7, s5, 32
s_add_u32 s7, s7, s25
s_lshl_b32 s7, s7, 10
s_add_u32 s7, s7, 4194304
v_add_u32 v86, s7, v105
v_cmp_eq_u32 vcc, 48, v100
ds_read_b32 v4, v84 offset:784
ds_read_b32 v5, v84 offset:1584
ds_read_b32 v6, v84 offset:2384
ds_read_b32 v7, v84 offset:3184
ds_read_b128 v[8:11], v84 offset:768
ds_read_b128 v[12:15], v84 offset:1568
ds_read_b128 v[16:19], v84 offset:2368
ds_read_b128 v[20:23], v84 offset:3168
ds_read_b128 v[24:27], v85 offset:0
ds_read_b128 v[28:31], v85 offset:800
ds_read_b128 v[32:35], v85 offset:1600
ds_read_b128 v[36:39], v85 offset:2400
s_waitcnt lgkmcnt(8)
v_max_f32 v40, v4, v5
v_max3_f32 v40, v40, v6, v7
v_sub_f32 v4, v4, v40
v_sub_f32 v5, v5, v40
v_sub_f32 v6, v6, v40
v_sub_f32 v7, v7, v40
v_exp_f32 v42, v4
v_exp_f32 v44, v5
v_exp_f32 v46, v6
v_exp_f32 v48, v7
s_waitcnt lgkmcnt(4)
v_pk_add_f32 v[8:9], v[8:9], v[10:11]
v_pk_add_f32 v[12:13], v[12:13], v[14:15]
v_pk_add_f32 v[16:17], v[16:17], v[18:19]
v_pk_add_f32 v[20:21], v[20:21], v[22:23]
v_add_f32 v8, v8, v9
v_add_f32 v12, v12, v13
v_add_f32 v16, v16, v17
v_add_f32 v20, v20, v21
v_mul_f32 v41, v42, v8
v_fmac_f32 v41, v44, v12
v_fmac_f32 v41, v46, v16
v_fmac_f32 v41, v48, v20
s_waitcnt lgkmcnt(0)
v_pk_mul_f32 v[52:53], v[24:25], v[42:43] op_sel_hi:[1,0]
v_pk_mul_f32 v[54:55], v[26:27], v[42:43] op_sel_hi:[1,0]
v_pk_fma_f32 v[52:53], v[28:29], v[44:45], v[52:53] op_sel_hi:[1,0,1]
v_pk_fma_f32 v[54:55], v[30:31], v[44:45], v[54:55] op_sel_hi:[1,0,1]
v_pk_fma_f32 v[52:53], v[32:33], v[46:47], v[52:53] op_sel_hi:[1,0,1]
v_pk_fma_f32 v[54:55], v[34:35], v[46:47], v[54:55] op_sel_hi:[1,0,1]
v_pk_fma_f32 v[52:53], v[36:37], v[48:49], v[52:53] op_sel_hi:[1,0,1]
v_pk_fma_f32 v[54:55], v[38:39], v[48:49], v[54:55] op_sel_hi:[1,0,1]
v_cndmask_b32 v52, v52, v40, vcc
v_cndmask_b32 v53, v53, v41, vcc
s_waitcnt vmcnt(0)
s_mov_b32 exec_hi, 0x1ffff
global_store_dwordx4 v86, v[52:55], s[50:51] sc1
s_mov_b32 exec_hi, -1
v_readfirstlane_b32 s4, v62
s_cmp_lg_u32 s4, 31
s_cbranch_scc1 L_end_standalone__kv_cache_quant_int4_int2_kv_with_per_channel_or_per_token_scales__decode_kernel
s_mul_i32 s5, s24, 4
s_add_u32 s5, s5, s3
L_poll_standalone__kv_cache_quant_int4_int2_kv_with_per_channel_or_per_token_scales__decode_kernel:
s_mul_i32 s7, s5, 32768
s_add_u32 s7, s7, 4194304
s_add_u32 s52, s50, s7
s_addc_u32 s53, s51, 0
v_lshlrev_b32 v4, 10, v100
v_mov_b32 v6, 0xff800000
v_mov_b32 v7, 0
s_mov_b32 exec_hi, 0
global_load_dwordx2 v[6:7], v4, s[52:53] offset:768 sc1
s_mov_b32 exec_lo, -1
s_mov_b32 exec_hi, 0xffff
global_load_dwordx4 v[112:115], v105, s[52:53] offset:0 sc1
global_load_dwordx4 v[116:119], v105, s[52:53] offset:1024 sc1
global_load_dwordx4 v[120:123], v105, s[52:53] offset:2048 sc1
global_load_dwordx4 v[124:127], v105, s[52:53] offset:3072 sc1
s_add_u32 s52, s52, 4096
s_addc_u32 s53, s53, 0
global_load_dwordx4 v[128:131], v105, s[52:53] offset:0 sc1
global_load_dwordx4 v[132:135], v105, s[52:53] offset:1024 sc1
global_load_dwordx4 v[136:139], v105, s[52:53] offset:2048 sc1
global_load_dwordx4 v[140:143], v105, s[52:53] offset:3072 sc1
s_add_u32 s52, s52, 4096
s_addc_u32 s53, s53, 0
global_load_dwordx4 v[144:147], v105, s[52:53] offset:0 sc1
global_load_dwordx4 v[148:151], v105, s[52:53] offset:1024 sc1
global_load_dwordx4 v[152:155], v105, s[52:53] offset:2048 sc1
global_load_dwordx4 v[156:159], v105, s[52:53] offset:3072 sc1
s_add_u32 s52, s52, 4096
s_addc_u32 s53, s53, 0
global_load_dwordx4 v[160:163], v105, s[52:53] offset:0 sc1
global_load_dwordx4 v[164:167], v105, s[52:53] offset:1024 sc1
global_load_dwordx4 v[168:171], v105, s[52:53] offset:2048 sc1
global_load_dwordx4 v[172:175], v105, s[52:53] offset:3072 sc1
s_add_u32 s52, s52, 4096
s_addc_u32 s53, s53, 0
global_load_dwordx4 v[176:179], v105, s[52:53] offset:0 sc1
global_load_dwordx4 v[180:183], v105, s[52:53] offset:1024 sc1
global_load_dwordx4 v[184:187], v105, s[52:53] offset:2048 sc1
global_load_dwordx4 v[188:191], v105, s[52:53] offset:3072 sc1
s_add_u32 s52, s52, 4096
s_addc_u32 s53, s53, 0
global_load_dwordx4 v[192:195], v105, s[52:53] offset:0 sc1
global_load_dwordx4 v[196:199], v105, s[52:53] offset:1024 sc1
global_load_dwordx4 v[200:203], v105, s[52:53] offset:2048 sc1
global_load_dwordx4 v[204:207], v105, s[52:53] offset:3072 sc1
s_add_u32 s52, s52, 4096
s_addc_u32 s53, s53, 0
global_load_dwordx4 v[208:211], v105, s[52:53] offset:0 sc1
global_load_dwordx4 v[212:215], v105, s[52:53] offset:1024 sc1
global_load_dwordx4 v[216:219], v105, s[52:53] offset:2048 sc1
global_load_dwordx4 v[220:223], v105, s[52:53] offset:3072 sc1
s_add_u32 s52, s52, 4096
s_addc_u32 s53, s53, 0
global_load_dwordx4 v[224:227], v105, s[52:53] offset:0 sc1
global_load_dwordx4 v[228:231], v105, s[52:53] offset:1024 sc1
global_load_dwordx4 v[232:235], v105, s[52:53] offset:2048 sc1
global_load_dwordx4 v[236:239], v105, s[52:53] offset:3072 sc1
s_add_u32 s52, s52, 4096
s_addc_u32 s53, s53, 0
s_mov_b32 exec_hi, -1
s_waitcnt vmcnt(32)
v_max_u32 v11, v6, v7
v_mov_b32 v8, v6
s_nop 1
v_max_f32_dpp v8, v8, v8 row_ror:8 row_mask:0xf bank_mask:0xf
s_nop 1
v_max_f32_dpp v8, v8, v8 row_ror:4 row_mask:0xf bank_mask:0xf
s_nop 1
v_max_f32_dpp v8, v8, v8 row_ror:2 row_mask:0xf bank_mask:0xf
s_nop 1
v_max_f32_dpp v8, v8, v8 row_ror:1 row_mask:0xf bank_mask:0xf
s_nop 1
v_mov_b32 v9, v8
s_nop 1
v_permlane32_swap_b32 v8, v9
s_nop 1
v_max_f32 v8, v8, v9
v_mov_b32 v9, v8
s_nop 1
v_permlane16_swap_b32 v8, v9
s_nop 1
v_max_f32 v8, v8, v9
v_sub_f32 v6, v6, v8
v_exp_f32 v6, v6
s_nop 0
v_mul_f32 v8, v6, v7
s_nop 1
v_add_f32_dpp v8, v8, v8 row_ror:8 row_mask:0xf bank_mask:0xf
s_nop 1
v_add_f32_dpp v8, v8, v8 row_ror:4 row_mask:0xf bank_mask:0xf
s_nop 1
v_add_f32_dpp v8, v8, v8 row_ror:2 row_mask:0xf bank_mask:0xf
s_nop 1
v_add_f32_dpp v8, v8, v8 row_ror:1 row_mask:0xf bank_mask:0xf
s_nop 1
v_mov_b32 v9, v8
s_nop 1
v_permlane32_swap_b32 v8, v9
s_nop 1
v_add_f32 v8, v8, v9
v_mov_b32 v9, v8
s_nop 1
v_permlane16_swap_b32 v8, v9
s_nop 1
v_add_f32 v8, v8, v9
v_rcp_f32 v10, v8
v_mov_b32 v12, 0
v_mov_b32 v13, 0
v_mov_b32 v14, 0
v_mov_b32 v15, 0
v_readlane_b32 s56, v6, 0
v_readlane_b32 s57, v6, 1
v_readlane_b32 s58, v6, 2
v_readlane_b32 s59, v6, 3
v_readlane_b32 s60, v6, 4
v_readlane_b32 s61, v6, 5
v_readlane_b32 s62, v6, 6
v_readlane_b32 s63, v6, 7
v_readlane_b32 s64, v6, 8
v_readlane_b32 s65, v6, 9
v_readlane_b32 s66, v6, 10
v_readlane_b32 s67, v6, 11
v_readlane_b32 s68, v6, 12
v_readlane_b32 s69, v6, 13
v_readlane_b32 s70, v6, 14
v_readlane_b32 s71, v6, 15
v_readlane_b32 s72, v6, 16
v_readlane_b32 s73, v6, 17
v_readlane_b32 s74, v6, 18
v_readlane_b32 s75, v6, 19
v_readlane_b32 s76, v6, 20
v_readlane_b32 s77, v6, 21
v_readlane_b32 s78, v6, 22
v_readlane_b32 s79, v6, 23
v_readlane_b32 s80, v6, 24
v_readlane_b32 s81, v6, 25
v_readlane_b32 s82, v6, 26
v_readlane_b32 s83, v6, 27
v_readlane_b32 s84, v6, 28
v_readlane_b32 s85, v6, 29
v_readlane_b32 s86, v6, 30
v_readlane_b32 s87, v6, 31
s_mov_b32 exec_hi, 0xffff
s_waitcnt vmcnt(28)
v_pk_fma_f32 v[12:13], v[112:113], s[56:57], v[12:13] op_sel_hi:[1,0,1]
v_pk_fma_f32 v[14:15], v[114:115], s[56:57], v[14:15] op_sel_hi:[1,0,1]
v_max3_u32 v11, v11, v112, v113
v_max3_u32 v11, v11, v114, v115
v_pk_fma_f32 v[12:13], v[116:117], s[56:57], v[12:13] op_sel:[0,1,0] op_sel_hi:[1,1,1]
v_pk_fma_f32 v[14:15], v[118:119], s[56:57], v[14:15] op_sel:[0,1,0] op_sel_hi:[1,1,1]
v_max3_u32 v11, v11, v116, v117
v_max3_u32 v11, v11, v118, v119
v_pk_fma_f32 v[12:13], v[120:121], s[58:59], v[12:13] op_sel_hi:[1,0,1]
v_pk_fma_f32 v[14:15], v[122:123], s[58:59], v[14:15] op_sel_hi:[1,0,1]
v_max3_u32 v11, v11, v120, v121
v_max3_u32 v11, v11, v122, v123
v_pk_fma_f32 v[12:13], v[124:125], s[58:59], v[12:13] op_sel:[0,1,0] op_sel_hi:[1,1,1]
v_pk_fma_f32 v[14:15], v[126:127], s[58:59], v[14:15] op_sel:[0,1,0] op_sel_hi:[1,1,1]
v_max3_u32 v11, v11, v124, v125
v_max3_u32 v11, v11, v126, v127
s_waitcnt vmcnt(24)
v_pk_fma_f32 v[12:13], v[128:129], s[60:61], v[12:13] op_sel_hi:[1,0,1]
v_pk_fma_f32 v[14:15], v[130:131], s[60:61], v[14:15] op_sel_hi:[1,0,1]
v_max3_u32 v11, v11, v128, v129
v_max3_u32 v11, v11, v130, v131
v_pk_fma_f32 v[12:13], v[132:133], s[60:61], v[12:13] op_sel:[0,1,0] op_sel_hi:[1,1,1]
v_pk_fma_f32 v[14:15], v[134:135], s[60:61], v[14:15] op_sel:[0,1,0] op_sel_hi:[1,1,1]
v_max3_u32 v11, v11, v132, v133
v_max3_u32 v11, v11, v134, v135
v_pk_fma_f32 v[12:13], v[136:137], s[62:63], v[12:13] op_sel_hi:[1,0,1]
v_pk_fma_f32 v[14:15], v[138:139], s[62:63], v[14:15] op_sel_hi:[1,0,1]
v_max3_u32 v11, v11, v136, v137
v_max3_u32 v11, v11, v138, v139
v_pk_fma_f32 v[12:13], v[140:141], s[62:63], v[12:13] op_sel:[0,1,0] op_sel_hi:[1,1,1]
v_pk_fma_f32 v[14:15], v[142:143], s[62:63], v[14:15] op_sel:[0,1,0] op_sel_hi:[1,1,1]
v_max3_u32 v11, v11, v140, v141
v_max3_u32 v11, v11, v142, v143
s_waitcnt vmcnt(20)
v_pk_fma_f32 v[12:13], v[144:145], s[64:65], v[12:13] op_sel_hi:[1,0,1]
v_pk_fma_f32 v[14:15], v[146:147], s[64:65], v[14:15] op_sel_hi:[1,0,1]
v_max3_u32 v11, v11, v144, v145
v_max3_u32 v11, v11, v146, v147
v_pk_fma_f32 v[12:13], v[148:149], s[64:65], v[12:13] op_sel:[0,1,0] op_sel_hi:[1,1,1]
v_pk_fma_f32 v[14:15], v[150:151], s[64:65], v[14:15] op_sel:[0,1,0] op_sel_hi:[1,1,1]
v_max3_u32 v11, v11, v148, v149
v_max3_u32 v11, v11, v150, v151
v_pk_fma_f32 v[12:13], v[152:153], s[66:67], v[12:13] op_sel_hi:[1,0,1]
v_pk_fma_f32 v[14:15], v[154:155], s[66:67], v[14:15] op_sel_hi:[1,0,1]
v_max3_u32 v11, v11, v152, v153
v_max3_u32 v11, v11, v154, v155
v_pk_fma_f32 v[12:13], v[156:157], s[66:67], v[12:13] op_sel:[0,1,0] op_sel_hi:[1,1,1]
v_pk_fma_f32 v[14:15], v[158:159], s[66:67], v[14:15] op_sel:[0,1,0] op_sel_hi:[1,1,1]
v_max3_u32 v11, v11, v156, v157
v_max3_u32 v11, v11, v158, v159
s_waitcnt vmcnt(16)
v_pk_fma_f32 v[12:13], v[160:161], s[68:69], v[12:13] op_sel_hi:[1,0,1]
v_pk_fma_f32 v[14:15], v[162:163], s[68:69], v[14:15] op_sel_hi:[1,0,1]
v_max3_u32 v11, v11, v160, v161
v_max3_u32 v11, v11, v162, v163
v_pk_fma_f32 v[12:13], v[164:165], s[68:69], v[12:13] op_sel:[0,1,0] op_sel_hi:[1,1,1]
v_pk_fma_f32 v[14:15], v[166:167], s[68:69], v[14:15] op_sel:[0,1,0] op_sel_hi:[1,1,1]
v_max3_u32 v11, v11, v164, v165
v_max3_u32 v11, v11, v166, v167
v_pk_fma_f32 v[12:13], v[168:169], s[70:71], v[12:13] op_sel_hi:[1,0,1]
v_pk_fma_f32 v[14:15], v[170:171], s[70:71], v[14:15] op_sel_hi:[1,0,1]
v_max3_u32 v11, v11, v168, v169
v_max3_u32 v11, v11, v170, v171
v_pk_fma_f32 v[12:13], v[172:173], s[70:71], v[12:13] op_sel:[0,1,0] op_sel_hi:[1,1,1]
v_pk_fma_f32 v[14:15], v[174:175], s[70:71], v[14:15] op_sel:[0,1,0] op_sel_hi:[1,1,1]
v_max3_u32 v11, v11, v172, v173
v_max3_u32 v11, v11, v174, v175
s_waitcnt vmcnt(12)
v_pk_fma_f32 v[12:13], v[176:177], s[72:73], v[12:13] op_sel_hi:[1,0,1]
v_pk_fma_f32 v[14:15], v[178:179], s[72:73], v[14:15] op_sel_hi:[1,0,1]
v_max3_u32 v11, v11, v176, v177
v_max3_u32 v11, v11, v178, v179
v_pk_fma_f32 v[12:13], v[180:181], s[72:73], v[12:13] op_sel:[0,1,0] op_sel_hi:[1,1,1]
v_pk_fma_f32 v[14:15], v[182:183], s[72:73], v[14:15] op_sel:[0,1,0] op_sel_hi:[1,1,1]
v_max3_u32 v11, v11, v180, v181
v_max3_u32 v11, v11, v182, v183
v_pk_fma_f32 v[12:13], v[184:185], s[74:75], v[12:13] op_sel_hi:[1,0,1]
v_pk_fma_f32 v[14:15], v[186:187], s[74:75], v[14:15] op_sel_hi:[1,0,1]
v_max3_u32 v11, v11, v184, v185
v_max3_u32 v11, v11, v186, v187
v_pk_fma_f32 v[12:13], v[188:189], s[74:75], v[12:13] op_sel:[0,1,0] op_sel_hi:[1,1,1]
v_pk_fma_f32 v[14:15], v[190:191], s[74:75], v[14:15] op_sel:[0,1,0] op_sel_hi:[1,1,1]
v_max3_u32 v11, v11, v188, v189
v_max3_u32 v11, v11, v190, v191
s_waitcnt vmcnt(8)
v_pk_fma_f32 v[12:13], v[192:193], s[76:77], v[12:13] op_sel_hi:[1,0,1]
v_pk_fma_f32 v[14:15], v[194:195], s[76:77], v[14:15] op_sel_hi:[1,0,1]
v_max3_u32 v11, v11, v192, v193
v_max3_u32 v11, v11, v194, v195
v_pk_fma_f32 v[12:13], v[196:197], s[76:77], v[12:13] op_sel:[0,1,0] op_sel_hi:[1,1,1]
v_pk_fma_f32 v[14:15], v[198:199], s[76:77], v[14:15] op_sel:[0,1,0] op_sel_hi:[1,1,1]
v_max3_u32 v11, v11, v196, v197
v_max3_u32 v11, v11, v198, v199
v_pk_fma_f32 v[12:13], v[200:201], s[78:79], v[12:13] op_sel_hi:[1,0,1]
v_pk_fma_f32 v[14:15], v[202:203], s[78:79], v[14:15] op_sel_hi:[1,0,1]
v_max3_u32 v11, v11, v200, v201
v_max3_u32 v11, v11, v202, v203
v_pk_fma_f32 v[12:13], v[204:205], s[78:79], v[12:13] op_sel:[0,1,0] op_sel_hi:[1,1,1]
v_pk_fma_f32 v[14:15], v[206:207], s[78:79], v[14:15] op_sel:[0,1,0] op_sel_hi:[1,1,1]
v_max3_u32 v11, v11, v204, v205
v_max3_u32 v11, v11, v206, v207
s_waitcnt vmcnt(4)
v_pk_fma_f32 v[12:13], v[208:209], s[80:81], v[12:13] op_sel_hi:[1,0,1]
v_pk_fma_f32 v[14:15], v[210:211], s[80:81], v[14:15] op_sel_hi:[1,0,1]
v_max3_u32 v11, v11, v208, v209
v_max3_u32 v11, v11, v210, v211
v_pk_fma_f32 v[12:13], v[212:213], s[80:81], v[12:13] op_sel:[0,1,0] op_sel_hi:[1,1,1]
v_pk_fma_f32 v[14:15], v[214:215], s[80:81], v[14:15] op_sel:[0,1,0] op_sel_hi:[1,1,1]
v_max3_u32 v11, v11, v212, v213
v_max3_u32 v11, v11, v214, v215
v_pk_fma_f32 v[12:13], v[216:217], s[82:83], v[12:13] op_sel_hi:[1,0,1]
v_pk_fma_f32 v[14:15], v[218:219], s[82:83], v[14:15] op_sel_hi:[1,0,1]
v_max3_u32 v11, v11, v216, v217
v_max3_u32 v11, v11, v218, v219
v_pk_fma_f32 v[12:13], v[220:221], s[82:83], v[12:13] op_sel:[0,1,0] op_sel_hi:[1,1,1]
v_pk_fma_f32 v[14:15], v[222:223], s[82:83], v[14:15] op_sel:[0,1,0] op_sel_hi:[1,1,1]
v_max3_u32 v11, v11, v220, v221
v_max3_u32 v11, v11, v222, v223
s_waitcnt vmcnt(0)
v_pk_fma_f32 v[12:13], v[224:225], s[84:85], v[12:13] op_sel_hi:[1,0,1]
v_pk_fma_f32 v[14:15], v[226:227], s[84:85], v[14:15] op_sel_hi:[1,0,1]
v_max3_u32 v11, v11, v224, v225
v_max3_u32 v11, v11, v226, v227
v_pk_fma_f32 v[12:13], v[228:229], s[84:85], v[12:13] op_sel:[0,1,0] op_sel_hi:[1,1,1]
v_pk_fma_f32 v[14:15], v[230:231], s[84:85], v[14:15] op_sel:[0,1,0] op_sel_hi:[1,1,1]
v_max3_u32 v11, v11, v228, v229
v_max3_u32 v11, v11, v230, v231
v_pk_fma_f32 v[12:13], v[232:233], s[86:87], v[12:13] op_sel_hi:[1,0,1]
v_pk_fma_f32 v[14:15], v[234:235], s[86:87], v[14:15] op_sel_hi:[1,0,1]
v_max3_u32 v11, v11, v232, v233
v_max3_u32 v11, v11, v234, v235
v_pk_fma_f32 v[12:13], v[236:237], s[86:87], v[12:13] op_sel:[0,1,0] op_sel_hi:[1,1,1]
v_pk_fma_f32 v[14:15], v[238:239], s[86:87], v[14:15] op_sel:[0,1,0] op_sel_hi:[1,1,1]
v_max3_u32 v11, v11, v236, v237
v_max3_u32 v11, v11, v238, v239
s_mov_b32 exec_hi, -1
v_cmp_eq_u32 vcc, 0xffffdead, v11
s_cbranch_vccnz L_poll_standalone__kv_cache_quant_int4_int2_kv_with_per_channel_or_per_token_scales__decode_kernel
s_mov_b32 exec_hi, 0xffff
v_pk_mul_f32 v[12:13], v[12:13], v[10:11] op_sel_hi:[1,0]
v_pk_mul_f32 v[14:15], v[14:15], v[10:11] op_sel_hi:[1,0]
v_cvt_pk_bf16_f32 v16, v12, v13
v_cvt_pk_bf16_f32 v17, v14, v15
s_add_u32 s7, s3, 0
s_mul_i32 s7, s7, 8
s_add_u32 s7, s7, s24
s_mul_i32 s7, s7, 384
v_add_u32 v20, s7, v104
global_store_dwordx2 v20, v[16:17], s[46:47]
s_mov_b32 exec_hi, -1
s_add_u32 s5, s5, 4
L_end_standalone__kv_cache_quant_int4_int2_kv_with_per_channel_or_per_token_scales__decode_kernel:
L_exit_standalone__kv_cache_quant_int4_int2_kv_with_per_channel_or_per_token_scales__decode_kernel:
s_endpgm
.section .rodata,"a"
.p2align 6
.amdhsa_kernel standalone__kv_cache_quant_int4_int2_kv_with_per_channel_or_per_token_scales__decode_kernel
  .amdhsa_next_free_vgpr 256
  .amdhsa_next_free_sgpr 102
  .amdhsa_accum_offset 256
  .amdhsa_group_segment_fixed_size 0
  .amdhsa_kernarg_size 80
  .amdhsa_user_sgpr_count 2
  .amdhsa_user_sgpr_kernarg_segment_ptr 1
  .amdhsa_system_sgpr_workgroup_id_x 1
.end_amdhsa_kernel
```
